```python
import torch

def _softmax(x, axis=-1):
    return torch.softmax(x, dim=axis)
def _gelu(x):
    return torch.nn.functional.gelu(x, approximate="tanh")
def _silu(x):
    return torch.nn.functional.silu(x)
def _sigmoid(x):
    return torch.sigmoid(x)
def _layernorm(x, axis=-1, eps=1e-5):
    m = x.mean(dim=axis, keepdim=True)
    v = x.var(dim=axis, keepdim=True, unbiased=False)
    return (x - m) / torch.sqrt(v + eps)
def _scatter_add(tgt, idx, src, axis=0):
    return tgt.clone().index_add_(axis, idx, src)
def _segment_sum(src, seg, n):
    out = torch.zeros((n,) + src.shape[1:], dtype=src.dtype)
    return out.index_add_(0, seg, src)
def _pad(x, pw):
    flat = tuple(v for pair in reversed(pw) for v in pair)
    return torch.nn.functional.pad(x, flat)

kernel_name = 'parallel_sum__ssm_conv_s5__dense_activation_silu__prompt'

def setup_inputs():

    _w = (lambda a: (lambda t: t.to(torch.bfloat16) if t.is_floating_point() else t)(torch.as_tensor(a)))
    def _A_setup():
        B, S, D = 1, 2048, 448
        P = D
        Lambda_re = -0.5 * (lambda _x: torch.exp(torch.as_tensor(_x)))((lambda *s: torch.randn(*s, dtype=torch.bfloat16) * 0.2)(P))
        Lambda_im = (lambda *s: torch.randn(*s, dtype=torch.bfloat16) * 0.8)(P) * 1.0
        B_re = (lambda *s: torch.randn(*s, dtype=torch.bfloat16) * 0.2)(P, D) * (D ** -0.5)
        B_im = (lambda *s: torch.randn(*s, dtype=torch.bfloat16) * 0.2)(P, D) * (D ** -0.5)
        C_re = (lambda *s: torch.randn(*s, dtype=torch.bfloat16) * 0.2)(D, P) * (P ** -0.5)
        C_im = (lambda *s: torch.randn(*s, dtype=torch.bfloat16) * 0.2)(D, P) * (P ** -0.5)
        log_dt = (lambda *s: torch.randn(*s, dtype=torch.bfloat16) * 0.2)(P) * 0.3 - 2.0
        Dskip = (lambda *s: torch.randn(*s, dtype=torch.bfloat16) * 0.05)(D)
        return {
            "x": _w((lambda *s: torch.randn(*s, dtype=torch.bfloat16) * 0.05)(B, S, D)),
            "Lambda_re": _w(Lambda_re),
            "Lambda_im": _w(Lambda_im),
            "B_re": _w(B_re),
            "B_im": _w(B_im),
            "C_re": _w(C_re),
            "C_im": _w(C_im),
            "log_dt": _w(log_dt),
            "Dskip": _w(Dskip),
        }
    _A_in = _A_setup()

    def _B_setup():
        B, S, D, F = 1, 2048, 448, 1792
        return {
            "x": _w((lambda *s: torch.randn(*s, dtype=torch.bfloat16) * 0.05)(B, S, D)),
            "w1": _w((lambda *s: torch.randn(*s, dtype=torch.bfloat16) * 0.8)(D, F) * (D ** -0.5)),
            "w2": _w((lambda *s: torch.randn(*s, dtype=torch.bfloat16) * 0.2)(F, D) * (F ** -0.5)),
        }
    _B_in = _B_setup()

    return {
        "A_x": _A_in["x"],
        "A_Lambda_re": _A_in["Lambda_re"],
        "A_Lambda_im": _A_in["Lambda_im"],
        "A_B_re": _A_in["B_re"],
        "A_B_im": _A_in["B_im"],
        "A_C_re": _A_in["C_re"],
        "A_C_im": _A_in["C_im"],
        "A_log_dt": _A_in["log_dt"],
        "A_Dskip": _A_in["Dskip"],
        "B_x": _B_in["x"],
        "B_w1": _B_in["w1"],
        "B_w2": _B_in["w2"],
    }

def reference(A_x, A_Lambda_re, A_Lambda_im, A_B_re, A_B_im, A_C_re, A_C_im, A_log_dt, A_Dskip, B_x, B_w1, B_w2):
    def _A_ref(x, Lambda_re, Lambda_im, B_re, B_im, C_re, C_im, log_dt, Dskip):
        Bsz, L, H = x.shape
        Lam = Lambda_re + 1j * Lambda_im
        Bmat = B_re + 1j * B_im
        Cmat = C_re + 1j * C_im
        dt = torch.exp(log_dt)
        Lam_bar = torch.exp(dt * Lam)
        B_bar = ((Lam_bar - 1.0) / Lam)[:, None] * Bmat
        Bu = torch.einsum("bld,pd->blp", x + 0j, B_bar)
        h = torch.zeros_like(Bu[:, 0, :])
        hs = []
        for t in range(L):
            h = Lam_bar[None, :] * h + Bu[:, t, :]
            hs.append(h)
        hseq = torch.stack(hs, 1)
        y = 2.0 * torch.einsum("blp,dp->bld", hseq, Cmat).real + x * Dskip[None, None, :]
        return y

    def _B_ref(x, w1, w2):
        h = torch.einsum("bsd,df->bsf", x, w1)
        h = _silu(h)
        out = torch.einsum("bsf,fd->bsd", h, w2)
        return out

    x = A_x
    xn = _layernorm(x, axis=-1)
    return x + _A_ref(xn, A_Lambda_re, A_Lambda_im, A_B_re, A_B_im, A_C_re, A_C_im, A_log_dt, A_Dskip) + _B_ref(xn, B_w1, B_w2)
```

```asm
; @launch grid=(256,1,1) block=(256,1,1) lds=163840
.amdgcn_target "amdgcn-amd-amdhsa--gfx950"
.text
.globl parallel_sum__ssm_conv_s5__dense_activation_silu__prompt_kernel
.p2align 8
.type parallel_sum__ssm_conv_s5__dense_activation_silu__prompt_kernel,@function
parallel_sum__ssm_conv_s5__dense_activation_silu__prompt_kernel:
    s_cmp_ge_u32 s2, 256
    s_cbranch_scc1 L_exit
    s_load_dwordx16 s[16:31], s[0:1], 0
    s_load_dwordx8 s[32:39], s[0:1], 64
    s_load_dwordx2 s[4:5], s[0:1], 96
    s_load_dwordx2 s[6:7], s[0:1], 112
    s_getpc_b64 s[80:81]
L_pc:
    v_lshrrev_b32 v4, 5, v0
    v_and_b32 v4, 6, v4
    v_and_b32 v5, 1, v0
    v_add_lshl_u32 v5, v4, v5, 7
    s_sub_u32 s80, s80, L_pc-parallel_sum__ssm_conv_s5__dense_activation_silu__prompt_kernel
    s_subb_u32 s81, s81, 0
    s_lshr_b32 s99, s2, 3
    s_lshl_b32 s99, s99, 10
    v_add_u32 v5, s99, v5
    v_min_u32 v5, L_code_end-parallel_sum__ssm_conv_s5__dense_activation_silu__prompt_kernel-4, v5
    v_mov_b32 v185, s81
    v_add_co_u32 v184, vcc, s80, v5
    s_nop 1
    v_addc_co_u32 v185, vcc, 0, v185, vcc
    s_mov_b64 exec, 3
    global_load_dword v176, v[184:185], off
    s_mov_b64 exec, -1
    v_lshrrev_b32 v3, 6, v0
    v_and_b32 v1, 63, v0
    v_readfirstlane_b32 s10, v3
    v_lshlrev_b32 v2, 4, v1
    v_mov_b32 v11, 0
    v_lshrrev_b32 v12, 5, v1
    v_and_b32 v13, 31, v1
    s_and_b32 s98, s2, 7
    s_lshr_b32 s99, s2, 3
    s_mov_b32 s14, 0x3f803f80
    s_mov_b32 s15, 0xffff0000
    v_lshrrev_b32 v3, 3, v1
    v_mul_u32_u24 v3, 896, v3
    v_lshrrev_b32 v4, 4, v1
    v_and_b32 v5, 7, v1
    v_xor_b32 v4, v4, v5
    v_lshl_add_u32 v3, v4, 4, v3
    v_xor_b32 v4, 64, v3
    s_cmp_ge_u32 s99, 28
    s_cbranch_scc1 L_prep
    s_mov_b32 s78, s98
    s_mov_b32 s79, s99
    s_mul_i32 s101, s99, 37
    s_lshr_b32 s101, s101, 8
    s_mul_i32 s3, s101, 7
    s_sub_u32 s11, s99, s3
    s_lshr_b32 s8, s98, 1
    s_lshl_b32 s8, s8, 2
    s_add_u32 s8, s8, s101
    s_and_b32 s98, s98, 1
    s_mul_i32 s9, s98, 7
    s_add_u32 s9, s9, s11
    s_mul_i32 s100, s10, 24576
    s_add_u32 s100, s100, 8192
    s_lshl_b32 s84, s11, 7
    s_lshl_b32 s98, s8, 2
    s_add_u32 s98, s98, s10
    s_mul_i32 s99, s98, 28672
    v_add_u32 v192, s99, v3
    v_add_u32 v193, s99, v4
    v_add_u32 v194, 12288, v192
    v_add_u32 v193, 6144, v193
    v_add_u32 v195, 12288, v193
    s_add_u32 s85, s84, 128
    s_cmp_ge_u32 s85, 896
    s_cselect_b32 s85, 0, s85
    s_add_u32 s86, s85, 128
    s_cmp_ge_u32 s86, 896
    s_cselect_b32 s86, 0, s86
    s_add_u32 s87, s86, 128
    s_cmp_ge_u32 s87, 896
    s_cselect_b32 s87, 0, s87
    s_add_u32 s88, s87, 128
    s_cmp_ge_u32 s88, 896
    s_cselect_b32 s88, 0, s88
    s_add_u32 s89, s88, 128
    s_cmp_ge_u32 s89, 896
    s_cselect_b32 s89, 0, s89
    s_add_u32 s90, s89, 128
    s_cmp_ge_u32 s90, 896
    s_cselect_b32 s90, 0, s90
    s_waitcnt lgkmcnt(0)
    s_mov_b32 s40, s16
    s_mov_b32 s41, s17
    s_mov_b32 s42, 1835008
    s_mov_b32 s43, 0x20000
    s_add_u32 m0, s100, 0
    s_nop 0
    buffer_load_dwordx4 v192, s[40:43], s84 offen offset:0 lds
    buffer_load_dwordx4 v193, s[40:43], s84 offen offset:1024 lds
    buffer_load_dwordx4 v194, s[40:43], s84 offen offset:2048 lds
    buffer_load_dwordx4 v195, s[40:43], s84 offen offset:3072 lds
    s_add_u32 m0, s100, 4096
    s_nop 0
    buffer_load_dwordx4 v192, s[40:43], s85 offen offset:0 lds
    buffer_load_dwordx4 v193, s[40:43], s85 offen offset:1024 lds
    buffer_load_dwordx4 v194, s[40:43], s85 offen offset:2048 lds
    buffer_load_dwordx4 v195, s[40:43], s85 offen offset:3072 lds
    s_mov_b32 s44, s22
    s_mov_b32 s45, s23
    s_mov_b32 s46, 401408
    s_mov_b32 s47, 0x20000
    s_mov_b32 s48, s24
    s_mov_b32 s49, s25
    s_mov_b32 s50, 401408
    s_mov_b32 s51, 0x20000
    s_and_b32 s99, s10, 1
    s_lshl_b32 s99, s99, 6
    v_xor_b32 v196, s99, v3
    s_mul_i32 s99, s10, 7168
    s_mul_i32 s98, s9, 28672
    s_add_u32 s99, s99, s98
    v_add_u32 v196, s99, v196
    s_lshl_b32 s101, s101, 1
    s_lshl_b32 s91, s101, 12
    s_lshl_b32 s99, s10, 10
    s_add_u32 s91, s91, s99
    s_add_u32 s99, s99, 28672
    s_add_u32 s92, s91, 4096
    s_cmp_ge_u32 s92, s99
    s_cselect_b32 s98, 28672, 0
    s_sub_u32 s92, s92, s98
    s_add_u32 s93, s92, 4096
    s_cmp_ge_u32 s93, s99
    s_cselect_b32 s98, 28672, 0
    s_sub_u32 s93, s93, s98
    s_add_u32 s94, s93, 4096
    s_cmp_ge_u32 s94, s99
    s_cselect_b32 s98, 28672, 0
    s_sub_u32 s94, s94, s98
    s_add_u32 s95, s94, 4096
    s_cmp_ge_u32 s95, s99
    s_cselect_b32 s98, 28672, 0
    s_sub_u32 s95, s95, s98
    s_add_u32 s96, s95, 4096
    s_cmp_ge_u32 s96, s99
    s_cselect_b32 s98, 28672, 0
    s_sub_u32 s96, s96, s98
    s_add_u32 s97, s96, 4096
    s_cmp_ge_u32 s97, s99
    s_cselect_b32 s98, 28672, 0
    s_sub_u32 s97, s97, s98
    s_lshl_b32 s101, s101, 7
    s_add_u32 s101, s101, s84
    s_cmp_ge_u32 s101, 896
    s_cselect_b32 s98, 896, 0
    s_sub_u32 s101, s101, s98
    v_lshlrev_b32 v5, 1, v13
    s_lshl_b32 s99, s9, 6
    s_mov_b32 s82, s101
    s_add_u32 s101, s101, 128
    s_cmp_ge_u32 s101, 896
    s_cselect_b32 s101, 0, s101
    s_mov_b32 s83, s101
    s_add_u32 m0, s91, 106496
    s_mov_b32 s64, s18
    s_mov_b32 s65, s19
    s_mov_b32 s66, 896
    s_mov_b32 s67, 0x20000
    buffer_load_dwordx4 v196, s[44:47], s82 offen lds
    s_add_u32 m0, s91, 135168
    s_mov_b32 s68, s20
    s_mov_b32 s69, s21
    s_mov_b32 s70, 896
    s_mov_b32 s71, 0x20000
    buffer_load_dwordx4 v196, s[48:51], s82 offen lds
    s_mov_b32 s72, s30
    s_mov_b32 s73, s31
    s_mov_b32 s74, 896
    s_mov_b32 s75, 0x20000
    s_mov_b32 s56, s6
    s_mov_b32 s57, s7
    s_mov_b32 s58, 15204352
    s_mov_b32 s59, 0x20000
    s_mov_b32 s52, s36
    s_mov_b32 s53, s37
    s_mov_b32 s54, 1605632
    s_mov_b32 s55, 0x20000
    buffer_load_dwordx2 v[252:253], v11, s[56:59], 0 offen sc1
    buffer_load_ushort v224, v5, s[64:67], s99 offen
    buffer_load_ushort v225, v5, s[68:71], s99 offen
    buffer_load_ushort v226, v5, s[72:75], s99 offen
    s_and_b32 s18, s78, 1
    s_mov_b32 s76, s32
    s_mov_b32 s77, s33
    s_mov_b32 s78, 896
    s_mov_b32 s79, 0x20000
    s_mov_b32 s60, s4
    s_mov_b32 s61, s5
    s_mov_b32 s62, 3670016
    s_mov_b32 s63, 0x20000
    s_add_u32 s38, s101, 128
    s_cmp_ge_u32 s38, 896
    s_cselect_b32 s38, 0, s38
    s_add_u32 s39, s38, 128
    s_cmp_ge_u32 s39, 896
    s_cselect_b32 s39, 0, s39
    s_add_u32 s34, s39, 128
    s_cmp_ge_u32 s34, 896
    s_cselect_b32 s34, 0, s34
    s_add_u32 s35, s34, 128
    s_cmp_ge_u32 s35, 896
    s_cselect_b32 s35, 0, s35
    s_add_u32 s3, s35, 128
    s_cmp_ge_u32 s3, 896
    s_cselect_b32 s3, 0, s3
    v_lshrrev_b32 v3, 3, v1
    v_mul_u32_u24 v3, 3584, v3
    v_lshrrev_b32 v4, 2, v1
    v_and_b32 v4, 4, v4
    v_and_b32 v5, 7, v1
    v_xor_b32 v4, v4, v5
    v_lshl_add_u32 v3, v4, 4, v3
    s_mul_i32 s99, s10, 57344
    s_lshl_b32 s98, s9, 8
    s_add_u32 s99, s99, s98
    v_add_u32 v197, s99, v3
    v_add_u32 v198, 27648, v197
    v_lshrrev_b32 v3, 1, v13
    v_and_b32 v3, 7, v3
    v_xor_b32 v3, v3, v12
    v_lshlrev_b32 v3, 4, v3
    v_lshl_add_u32 v3, v13, 7, v3
    v_add_u32 v199, s100, v3
    v_xor_b32 v200, 32, v199
    v_xor_b32 v201, 64, v199
    v_xor_b32 v202, 96, v199
    v_lshrrev_b32 v3, 2, v1
    v_and_b32 v3, 3, v3
    v_lshlrev_b32 v4, 7, v3
    v_lshl_add_u32 v4, v12, 10, v4
    v_and_b32 v3, 2, v3
    v_lshl_add_u32 v4, v3, 5, v4
    v_and_b32 v3, 16, v1
    v_lshl_add_u32 v4, v3, 1, v4
    v_and_b32 v3, 3, v1
    v_lshl_add_u32 v203, v3, 3, v4
    v_add_u32 v203, 8192, v203
    v_xor_b32 v205, 64, v203
    v_add_u32 v204, 0x10000, v203
    v_add_u32 v206, 0x10000, v205
    s_mul_i32 s99, s10, 4608
    s_add_u32 s99, s99, 122880
    v_mul_u32_u24 v3, 72, v13
    v_lshl_add_u32 v3, v12, 3, v3
    v_add_u32 v222, s99, v3
    v_lshrrev_b32 v3, 2, v1
    v_and_b32 v3, 3, v3
    v_lshl_add_u32 v3, v12, 3, v3
    v_mul_u32_u24 v3, 72, v3
    v_and_b32 v4, 16, v1
    v_lshl_add_u32 v3, v4, 1, v3
    v_and_b32 v4, 3, v1
    v_lshl_add_u32 v3, v4, 3, v3
    v_add_u32 v223, s99, v3
    s_mov_b32 s17, s11
    s_lshl_b32 s98, s8, 2
    s_add_u32 s99, s98, s10
    s_mul_i32 s16, s99, 168
    s_lshl_b32 s101, s9, 1
    s_add_u32 s16, s16, s101
    s_lshl_b32 s16, s16, 10
    s_add_u32 s16, s16, 4194304
    s_lshl_b32 s25, s99, 7
    s_lshl_b32 s101, s9, 3
    s_add_u32 s25, s25, s101
    s_add_u32 s25, s25, 8192
    s_lshl_b32 s101, s18, 1
    s_add_u32 s19, s98, s101
    s_mul_i32 s101, s10, 7
    s_mul_i32 s22, s19, 168
    s_add_u32 s22, s22, s101
    s_lshl_b32 s22, s22, 10
    s_add_u32 s22, s22, 4194304
    s_add_u32 s23, s22, 172032
    s_mul_i32 s21, s17, 168
    s_add_u32 s21, s21, s101
    s_lshl_b32 s21, s21, 11
    s_add_u32 s21, s21, 1048576
    s_lshr_b32 s98, s101, 1
    s_lshl_b32 s20, 0x000f000f, s98
    s_lshl_b32 s98, s101, 11
    s_add_u32 s32, s21, s98
    s_lshl_b32 s98, s101, 10
    s_add_u32 s33, s22, s98
    v_and_b32 v3, 16, v1
    v_lshlrev_b32 v3, 3, v3
    v_and_b32 v4, 15, v1
    v_lshl_add_u32 v3, v4, 3, v3
    s_lshl_b32 s101, s19, 7
    s_add_u32 s101, s101, 8192
    v_add_u32 v14, s101, v3
    v_mov_b32 v232, 0
    v_mov_b32 v233, 0
    v_mov_b32 v234, 0
    v_mov_b32 v235, 0
    s_add_u32 m0, s100, 8192
    s_nop 0
    buffer_load_dwordx4 v192, s[40:43], s86 offen offset:0 lds
    buffer_load_dwordx4 v193, s[40:43], s86 offen offset:1024 lds
    buffer_load_dwordx4 v194, s[40:43], s86 offen offset:2048 lds
    buffer_load_dwordx4 v195, s[40:43], s86 offen offset:3072 lds
    s_add_u32 m0, s100, 12288
    s_nop 0
    buffer_load_dwordx4 v192, s[40:43], s87 offen offset:0 lds
    buffer_load_dwordx4 v193, s[40:43], s87 offen offset:1024 lds
    buffer_load_dwordx4 v194, s[40:43], s87 offen offset:2048 lds
    buffer_load_dwordx4 v195, s[40:43], s87 offen offset:3072 lds
    s_add_u32 m0, s100, 16384
    s_nop 0
    buffer_load_dwordx4 v192, s[40:43], s88 offen offset:0 lds
    buffer_load_dwordx4 v193, s[40:43], s88 offen offset:1024 lds
    buffer_load_dwordx4 v194, s[40:43], s88 offen offset:2048 lds
    buffer_load_dwordx4 v195, s[40:43], s88 offen offset:3072 lds
    s_add_u32 m0, s100, 20480
    s_nop 0
    buffer_load_dwordx4 v192, s[40:43], s89 offen offset:0 lds
    buffer_load_dwordx4 v193, s[40:43], s89 offen offset:1024 lds
    buffer_load_dwordx4 v194, s[40:43], s89 offen offset:2048 lds
    buffer_load_dwordx4 v195, s[40:43], s89 offen offset:3072 lds
    s_waitcnt vmcnt(26)
    ds_read_b128 v[16:19], v199 offset:0
    buffer_load_dwordx4 v[160:163], v192, s[40:43], s90 offen offset:0
    ds_read_b128 v[20:23], v200 offset:0
    ds_read_b128 v[24:27], v201 offset:0
    ds_read_b128 v[28:31], v202 offset:0
    s_waitcnt vmcnt(23)
    ds_read_b128 v[32:35], v199 offset:4096
    ds_read_b128 v[36:39], v200 offset:4096
    ds_read_b128 v[40:43], v201 offset:4096
    buffer_load_dwordx4 v[164:167], v193, s[40:43], s90 offen offset:1024
    ds_read_b128 v[44:47], v202 offset:4096
    s_waitcnt lgkmcnt(4)
    v_dot2c_f32_bf16 v232, s14, v16
    v_dot2c_f32_bf16 v234, v16, v16
    v_dot2c_f32_bf16 v233, s14, v17
    v_dot2c_f32_bf16 v235, v17, v17
    v_dot2c_f32_bf16 v232, s14, v18
    v_dot2c_f32_bf16 v234, v18, v18
    buffer_load_dwordx4 v[168:171], v194, s[40:43], s90 offen offset:2048
    v_dot2c_f32_bf16 v233, s14, v19
    v_dot2c_f32_bf16 v235, v19, v19
    v_dot2c_f32_bf16 v232, s14, v20
    v_dot2c_f32_bf16 v234, v20, v20
    v_dot2c_f32_bf16 v233, s14, v21
    v_dot2c_f32_bf16 v235, v21, v21
    v_dot2c_f32_bf16 v232, s14, v22
    buffer_load_dwordx4 v[172:175], v195, s[40:43], s90 offen offset:3072
    v_dot2c_f32_bf16 v234, v22, v22
    v_dot2c_f32_bf16 v233, s14, v23
    v_dot2c_f32_bf16 v235, v23, v23
    v_dot2c_f32_bf16 v232, s14, v24
    v_dot2c_f32_bf16 v234, v24, v24
    v_dot2c_f32_bf16 v233, s14, v25
    v_dot2c_f32_bf16 v235, v25, v25
    s_add_u32 m0, s92, 106496
    s_nop 0
    buffer_load_dwordx4 v196, s[44:47], s83 offen lds
    v_dot2c_f32_bf16 v232, s14, v26
    v_dot2c_f32_bf16 v234, v26, v26
    v_dot2c_f32_bf16 v233, s14, v27
    v_dot2c_f32_bf16 v235, v27, v27
    v_dot2c_f32_bf16 v232, s14, v28
    v_dot2c_f32_bf16 v234, v28, v28
    s_add_u32 m0, s92, 135168
    s_nop 0
    buffer_load_dwordx4 v196, s[48:51], s83 offen lds
    v_dot2c_f32_bf16 v233, s14, v29
    v_dot2c_f32_bf16 v235, v29, v29
    v_dot2c_f32_bf16 v232, s14, v30
    v_dot2c_f32_bf16 v234, v30, v30
    v_dot2c_f32_bf16 v233, s14, v31
    v_dot2c_f32_bf16 v235, v31, v31
    s_mul_i32 s98, s8, 14
    s_add_u32 s98, s98, s9
    s_lshl_b32 s98, s98, 2
    s_add_u32 s98, s98, s10
    s_mul_i32 s98, s98, 1792
    v_lshlrev_b32 v4, 7, v1
    s_mov_b64 exec, 0x3fff
    buffer_load_dword v181, v4, s[52:55], s98 offen
    s_mov_b64 exec, -1
    s_waitcnt vmcnt(19)
    ds_read_b128 v[48:51], v199 offset:8192
    ds_read_b128 v[52:55], v200 offset:8192
    ds_read_b128 v[56:59], v201 offset:8192
    ds_read_b128 v[60:63], v202 offset:8192
    s_waitcnt lgkmcnt(4)
    v_dot2c_f32_bf16 v232, s14, v32
    v_dot2c_f32_bf16 v234, v32, v32
    v_dot2c_f32_bf16 v233, s14, v33
    v_dot2c_f32_bf16 v235, v33, v33
    v_dot2c_f32_bf16 v232, s14, v34
    v_dot2c_f32_bf16 v234, v34, v34
    v_dot2c_f32_bf16 v233, s14, v35
    v_dot2c_f32_bf16 v235, v35, v35
    v_dot2c_f32_bf16 v232, s14, v36
    v_dot2c_f32_bf16 v234, v36, v36
    v_dot2c_f32_bf16 v233, s14, v37
    v_dot2c_f32_bf16 v235, v37, v37
    v_dot2c_f32_bf16 v232, s14, v38
    v_dot2c_f32_bf16 v234, v38, v38
    v_dot2c_f32_bf16 v233, s14, v39
    v_dot2c_f32_bf16 v235, v39, v39
    v_dot2c_f32_bf16 v232, s14, v40
    v_dot2c_f32_bf16 v234, v40, v40
    v_dot2c_f32_bf16 v233, s14, v41
    v_dot2c_f32_bf16 v235, v41, v41
    v_dot2c_f32_bf16 v232, s14, v42
    v_dot2c_f32_bf16 v234, v42, v42
    v_dot2c_f32_bf16 v233, s14, v43
    v_dot2c_f32_bf16 v235, v43, v43
    v_dot2c_f32_bf16 v232, s14, v44
    v_dot2c_f32_bf16 v234, v44, v44
    v_dot2c_f32_bf16 v233, s14, v45
    v_dot2c_f32_bf16 v235, v45, v45
    v_dot2c_f32_bf16 v232, s14, v46
    v_dot2c_f32_bf16 v234, v46, v46
    v_dot2c_f32_bf16 v233, s14, v47
    v_dot2c_f32_bf16 v235, v47, v47
    s_waitcnt vmcnt(15)
    ds_read_b128 v[64:67], v199 offset:12288
    ds_read_b128 v[68:71], v200 offset:12288
    ds_read_b128 v[72:75], v201 offset:12288
    ds_read_b128 v[76:79], v202 offset:12288
    s_waitcnt lgkmcnt(4)
    v_dot2c_f32_bf16 v232, s14, v48
    v_dot2c_f32_bf16 v234, v48, v48
    v_dot2c_f32_bf16 v233, s14, v49
    v_dot2c_f32_bf16 v235, v49, v49
    v_dot2c_f32_bf16 v232, s14, v50
    v_dot2c_f32_bf16 v234, v50, v50
    v_dot2c_f32_bf16 v233, s14, v51
    v_dot2c_f32_bf16 v235, v51, v51
    v_dot2c_f32_bf16 v232, s14, v52
    v_dot2c_f32_bf16 v234, v52, v52
    v_dot2c_f32_bf16 v233, s14, v53
    v_dot2c_f32_bf16 v235, v53, v53
    v_dot2c_f32_bf16 v232, s14, v54
    v_dot2c_f32_bf16 v234, v54, v54
    v_dot2c_f32_bf16 v233, s14, v55
    v_dot2c_f32_bf16 v235, v55, v55
    v_dot2c_f32_bf16 v232, s14, v56
    v_dot2c_f32_bf16 v234, v56, v56
    v_dot2c_f32_bf16 v233, s14, v57
    v_dot2c_f32_bf16 v235, v57, v57
    v_dot2c_f32_bf16 v232, s14, v58
    v_dot2c_f32_bf16 v234, v58, v58
    v_dot2c_f32_bf16 v233, s14, v59
    v_dot2c_f32_bf16 v235, v59, v59
    v_dot2c_f32_bf16 v232, s14, v60
    v_dot2c_f32_bf16 v234, v60, v60
    v_dot2c_f32_bf16 v233, s14, v61
    v_dot2c_f32_bf16 v235, v61, v61
    v_dot2c_f32_bf16 v232, s14, v62
    v_dot2c_f32_bf16 v234, v62, v62
    v_dot2c_f32_bf16 v233, s14, v63
    v_dot2c_f32_bf16 v235, v63, v63
    s_waitcnt vmcnt(11)
    ds_read_b128 v[80:83], v199 offset:16384
    ds_read_b128 v[84:87], v200 offset:16384
    ds_read_b128 v[88:91], v201 offset:16384
    ds_read_b128 v[92:95], v202 offset:16384
    s_waitcnt lgkmcnt(4)
    v_dot2c_f32_bf16 v232, s14, v64
    v_dot2c_f32_bf16 v234, v64, v64
    v_dot2c_f32_bf16 v233, s14, v65
    v_dot2c_f32_bf16 v235, v65, v65
    v_dot2c_f32_bf16 v232, s14, v66
    v_dot2c_f32_bf16 v234, v66, v66
    v_dot2c_f32_bf16 v233, s14, v67
    v_dot2c_f32_bf16 v235, v67, v67
    v_dot2c_f32_bf16 v232, s14, v68
    v_dot2c_f32_bf16 v234, v68, v68
    v_dot2c_f32_bf16 v233, s14, v69
    v_dot2c_f32_bf16 v235, v69, v69
    v_dot2c_f32_bf16 v232, s14, v70
    v_dot2c_f32_bf16 v234, v70, v70
    v_dot2c_f32_bf16 v233, s14, v71
    v_dot2c_f32_bf16 v235, v71, v71
    v_dot2c_f32_bf16 v232, s14, v72
    v_dot2c_f32_bf16 v234, v72, v72
    v_dot2c_f32_bf16 v233, s14, v73
    v_dot2c_f32_bf16 v235, v73, v73
    v_dot2c_f32_bf16 v232, s14, v74
    v_dot2c_f32_bf16 v234, v74, v74
    v_dot2c_f32_bf16 v233, s14, v75
    v_dot2c_f32_bf16 v235, v75, v75
    v_dot2c_f32_bf16 v232, s14, v76
    v_dot2c_f32_bf16 v234, v76, v76
    v_dot2c_f32_bf16 v233, s14, v77
    v_dot2c_f32_bf16 v235, v77, v77
    v_dot2c_f32_bf16 v232, s14, v78
    v_dot2c_f32_bf16 v234, v78, v78
    v_dot2c_f32_bf16 v233, s14, v79
    v_dot2c_f32_bf16 v235, v79, v79
    s_waitcnt vmcnt(7)
    ds_read_b128 v[96:99], v199 offset:20480
    ds_read_b128 v[100:103], v200 offset:20480
    ds_read_b128 v[104:107], v201 offset:20480
    ds_read_b128 v[108:111], v202 offset:20480
    s_waitcnt lgkmcnt(4)
    v_dot2c_f32_bf16 v232, s14, v80
    v_dot2c_f32_bf16 v234, v80, v80
    v_dot2c_f32_bf16 v233, s14, v81
    v_dot2c_f32_bf16 v235, v81, v81
    v_dot2c_f32_bf16 v232, s14, v82
    v_dot2c_f32_bf16 v234, v82, v82
    v_dot2c_f32_bf16 v233, s14, v83
    v_dot2c_f32_bf16 v235, v83, v83
    v_dot2c_f32_bf16 v232, s14, v84
    v_dot2c_f32_bf16 v234, v84, v84
    v_dot2c_f32_bf16 v233, s14, v85
    v_dot2c_f32_bf16 v235, v85, v85
    v_dot2c_f32_bf16 v232, s14, v86
    v_dot2c_f32_bf16 v234, v86, v86
    v_dot2c_f32_bf16 v233, s14, v87
    v_dot2c_f32_bf16 v235, v87, v87
    v_dot2c_f32_bf16 v232, s14, v88
    v_dot2c_f32_bf16 v234, v88, v88
    v_dot2c_f32_bf16 v233, s14, v89
    v_dot2c_f32_bf16 v235, v89, v89
    v_dot2c_f32_bf16 v232, s14, v90
    v_dot2c_f32_bf16 v234, v90, v90
    v_dot2c_f32_bf16 v233, s14, v91
    v_dot2c_f32_bf16 v235, v91, v91
    v_dot2c_f32_bf16 v232, s14, v92
    v_dot2c_f32_bf16 v234, v92, v92
    v_dot2c_f32_bf16 v233, s14, v93
    v_dot2c_f32_bf16 v235, v93, v93
    v_dot2c_f32_bf16 v232, s14, v94
    v_dot2c_f32_bf16 v234, v94, v94
    v_dot2c_f32_bf16 v233, s14, v95
    v_dot2c_f32_bf16 v235, v95, v95
    v_add_u32 v3, s100, v2
    s_waitcnt vmcnt(6)
    ds_write_b128 v3, v[160:163] offset:0
    s_waitcnt vmcnt(5)
    ds_write_b128 v3, v[164:167] offset:1024
    s_waitcnt vmcnt(4)
    ds_write_b128 v3, v[168:171] offset:2048
    s_waitcnt vmcnt(3)
    ds_write_b128 v3, v[172:175] offset:3072
    ds_read_b128 v[112:115], v199 offset:0
    ds_read_b128 v[116:119], v200 offset:0
    ds_read_b128 v[120:123], v201 offset:0
    ds_read_b128 v[124:127], v202 offset:0
    s_waitcnt lgkmcnt(8)
    v_dot2c_f32_bf16 v232, s14, v96
    v_dot2c_f32_bf16 v234, v96, v96
    v_dot2c_f32_bf16 v233, s14, v97
    v_dot2c_f32_bf16 v235, v97, v97
    v_dot2c_f32_bf16 v232, s14, v98
    v_dot2c_f32_bf16 v234, v98, v98
    v_dot2c_f32_bf16 v233, s14, v99
    v_dot2c_f32_bf16 v235, v99, v99
    v_dot2c_f32_bf16 v232, s14, v100
    v_dot2c_f32_bf16 v234, v100, v100
    v_dot2c_f32_bf16 v233, s14, v101
    v_dot2c_f32_bf16 v235, v101, v101
    v_dot2c_f32_bf16 v232, s14, v102
    v_dot2c_f32_bf16 v234, v102, v102
    v_dot2c_f32_bf16 v233, s14, v103
    v_dot2c_f32_bf16 v235, v103, v103
    v_dot2c_f32_bf16 v232, s14, v104
    v_dot2c_f32_bf16 v234, v104, v104
    v_dot2c_f32_bf16 v233, s14, v105
    v_dot2c_f32_bf16 v235, v105, v105
    v_dot2c_f32_bf16 v232, s14, v106
    v_dot2c_f32_bf16 v234, v106, v106
    v_dot2c_f32_bf16 v233, s14, v107
    v_dot2c_f32_bf16 v235, v107, v107
    v_dot2c_f32_bf16 v232, s14, v108
    v_dot2c_f32_bf16 v234, v108, v108
    v_dot2c_f32_bf16 v233, s14, v109
    v_dot2c_f32_bf16 v235, v109, v109
    v_dot2c_f32_bf16 v232, s14, v110
    v_dot2c_f32_bf16 v234, v110, v110
    v_dot2c_f32_bf16 v233, s14, v111
    v_dot2c_f32_bf16 v235, v111, v111
    s_waitcnt lgkmcnt(0)
    v_dot2c_f32_bf16 v232, s14, v112
    v_dot2c_f32_bf16 v234, v112, v112
    v_dot2c_f32_bf16 v233, s14, v113
    v_dot2c_f32_bf16 v235, v113, v113
    v_dot2c_f32_bf16 v232, s14, v114
    v_dot2c_f32_bf16 v234, v114, v114
    v_dot2c_f32_bf16 v233, s14, v115
    v_dot2c_f32_bf16 v235, v115, v115
    v_dot2c_f32_bf16 v232, s14, v116
    v_dot2c_f32_bf16 v234, v116, v116
    v_dot2c_f32_bf16 v233, s14, v117
    v_dot2c_f32_bf16 v235, v117, v117
    v_dot2c_f32_bf16 v232, s14, v118
    v_dot2c_f32_bf16 v234, v118, v118
    v_dot2c_f32_bf16 v233, s14, v119
    v_dot2c_f32_bf16 v235, v119, v119
    v_dot2c_f32_bf16 v232, s14, v120
    v_dot2c_f32_bf16 v234, v120, v120
    v_dot2c_f32_bf16 v233, s14, v121
    v_dot2c_f32_bf16 v235, v121, v121
    v_dot2c_f32_bf16 v232, s14, v122
    v_dot2c_f32_bf16 v234, v122, v122
    v_dot2c_f32_bf16 v233, s14, v123
    v_dot2c_f32_bf16 v235, v123, v123
    v_dot2c_f32_bf16 v232, s14, v124
    v_dot2c_f32_bf16 v234, v124, v124
    v_dot2c_f32_bf16 v233, s14, v125
    v_dot2c_f32_bf16 v235, v125, v125
    v_dot2c_f32_bf16 v232, s14, v126
    v_dot2c_f32_bf16 v234, v126, v126
    v_dot2c_f32_bf16 v233, s14, v127
    v_dot2c_f32_bf16 v235, v127, v127
    s_nop 1
    v_add_f32 v232, v232, v233
    s_add_u32 m0, s93, 106496
    s_nop 0
    buffer_load_dwordx4 v196, s[44:47], s38 offen lds
    v_add_f32 v234, v234, v235
    v_mov_b32 v233, v232
    v_mov_b32 v235, v234
    s_nop 0
    v_permlane32_swap_b32 v232, v233
    v_permlane32_swap_b32 v234, v235
    v_add_f32 v232, v232, v233
    v_add_f32 v234, v234, v235
    v_mul_f32 v232, 0x3b124925, v232
    v_mul_f32 v234, 0x3b124925, v234
    v_fma_f32 v234, -v232, v232, v234
    v_max_f32 v234, 0, v234
    v_cvt_pk_bf16_f32 v7, v232, v232
    v_lshlrev_b32 v7, 16, v7
    s_add_u32 m0, s93, 135168
    s_nop 0
    buffer_load_dwordx4 v196, s[48:51], s38 offen lds
    v_cvt_pk_bf16_f32 v234, v234, v234
    v_lshlrev_b32 v234, 16, v234
    v_add_f32 v234, 0x3727c5ac, v234
    v_cvt_pk_bf16_f32 v234, v234, v234
    v_lshlrev_b32 v234, 16, v234
    v_sqrt_f32 v234, v234
    s_nop 0
    v_cvt_pk_bf16_f32 v8, v234, v234
    v_lshlrev_b32 v8, 16, v8
    v_rcp_f32 v10, v8
    s_lshl_b32 s26, s10, 7
    v_lshl_add_u32 v3, v13, 2, s26
    v_mul_f32 v9, 0xbfb8aa3b, v10
    s_add_u32 m0, s94, 106496
    s_nop 0
    buffer_load_dwordx4 v196, s[44:47], s39 offen lds
    ds_write_b32 v3, v10 offset:0
    v_lshlrev_b32 v3, 1, v3
    v_mov_b32 v236, v7
    v_mov_b32 v237, v10
    ds_write_b64 v3, v[236:237] offset:512
    s_sub_u32 s27, 106496, s100
    v_add_u32 v199, s27, v199
    v_add_u32 v200, s27, v200
    v_add_u32 v201, s27, v201
    v_add_u32 v202, s27, v202
    v_sub_f32 v240, 0, v7
    s_mov_b32 s70, 0x3f80
    s_mov_b32 s71, 0x3f800000
    v_readfirstlane_b32 s12, v252
    v_readfirstlane_b32 s13, v253
    s_add_u32 m0, s94, 135168
    s_nop 0
    buffer_load_dwordx4 v196, s[48:51], s39 offen lds
    s_mul_i32 s12, s12, 0x9e3779b1
    s_add_u32 s12, s12, 0x7f4a7c15
    s_mul_i32 s13, s13, 0x85ebca6b
    s_add_u32 s13, s13, 0xc2b2ae35
    v_mov_b32 v254, s12
    v_mov_b32 v255, s13
    s_lshr_b32 s28, s17, 1
    s_lshl_b32 s28, s28, 8
    s_lshl_b32 s68, s17, 7
    s_add_u32 s68, s68, 4096
    s_sub_u32 s68, s68, s28
    s_add_u32 s28, s28, 49152
    v_lshl_add_u32 v252, v13, 3, s28
    s_mul_i32 s28, s10, 7
    s_lshl_b32 s69, 0x7f, s28
    s_add_u32 m0, s95, 106496
    s_nop 0
    buffer_load_dwordx4 v196, s[44:47], s34 offen lds
    v_dot2_f32_bf16 v232, v16, s70, v240
    v_dot2_f32_bf16 v233, v16, s71, v240
    v_dot2_f32_bf16 v234, v17, s70, v240
    v_dot2_f32_bf16 v235, v17, s71, v240
    v_dot2_f32_bf16 v236, v18, s70, v240
    v_dot2_f32_bf16 v237, v18, s71, v240
    v_dot2_f32_bf16 v238, v19, s70, v240
    v_dot2_f32_bf16 v239, v19, s71, v240
    v_cvt_pk_bf16_f32 v16, v232, v233
    v_cvt_pk_bf16_f32 v17, v234, v235
    v_cvt_pk_bf16_f32 v18, v236, v237
    v_cvt_pk_bf16_f32 v19, v238, v239
    v_dot2_f32_bf16 v232, v20, s70, v240
    v_dot2_f32_bf16 v233, v20, s71, v240
    s_add_u32 m0, s95, 135168
    s_nop 0
    buffer_load_dwordx4 v196, s[48:51], s34 offen lds
    v_dot2_f32_bf16 v234, v21, s70, v240
    v_dot2_f32_bf16 v235, v21, s71, v240
    v_dot2_f32_bf16 v236, v22, s70, v240
    v_dot2_f32_bf16 v237, v22, s71, v240
    v_dot2_f32_bf16 v238, v23, s70, v240
    v_dot2_f32_bf16 v239, v23, s71, v240
    v_cvt_pk_bf16_f32 v20, v232, v233
    v_cvt_pk_bf16_f32 v21, v234, v235
    v_cvt_pk_bf16_f32 v22, v236, v237
    v_cvt_pk_bf16_f32 v23, v238, v239
    v_dot2_f32_bf16 v232, v24, s70, v240
    v_dot2_f32_bf16 v233, v24, s71, v240
    v_dot2_f32_bf16 v234, v25, s70, v240
    v_dot2_f32_bf16 v235, v25, s71, v240
    s_add_u32 m0, s96, 106496
    s_nop 0
    buffer_load_dwordx4 v196, s[44:47], s35 offen lds
    v_dot2_f32_bf16 v236, v26, s70, v240
    v_dot2_f32_bf16 v237, v26, s71, v240
    v_dot2_f32_bf16 v238, v27, s70, v240
    v_dot2_f32_bf16 v239, v27, s71, v240
    v_cvt_pk_bf16_f32 v24, v232, v233
    v_cvt_pk_bf16_f32 v25, v234, v235
    v_cvt_pk_bf16_f32 v26, v236, v237
    v_cvt_pk_bf16_f32 v27, v238, v239
    v_dot2_f32_bf16 v232, v28, s70, v240
    v_dot2_f32_bf16 v233, v28, s71, v240
    v_dot2_f32_bf16 v234, v29, s70, v240
    v_dot2_f32_bf16 v235, v29, s71, v240
    v_dot2_f32_bf16 v236, v30, s70, v240
    v_dot2_f32_bf16 v237, v30, s71, v240
    s_add_u32 m0, s96, 135168
    s_nop 0
    buffer_load_dwordx4 v196, s[48:51], s35 offen lds
    v_dot2_f32_bf16 v238, v31, s70, v240
    v_dot2_f32_bf16 v239, v31, s71, v240
    v_cvt_pk_bf16_f32 v28, v232, v233
    v_cvt_pk_bf16_f32 v29, v234, v235
    v_cvt_pk_bf16_f32 v30, v236, v237
    v_cvt_pk_bf16_f32 v31, v238, v239
    v_dot2_f32_bf16 v232, v32, s70, v240
    v_dot2_f32_bf16 v233, v32, s71, v240
    v_dot2_f32_bf16 v234, v33, s70, v240
    v_dot2_f32_bf16 v235, v33, s71, v240
    v_dot2_f32_bf16 v236, v34, s70, v240
    v_dot2_f32_bf16 v237, v34, s71, v240
    v_dot2_f32_bf16 v238, v35, s70, v240
    v_dot2_f32_bf16 v239, v35, s71, v240
    s_add_u32 m0, s97, 106496
    s_nop 0
    buffer_load_dwordx4 v196, s[44:47], s3 offen lds
    v_cvt_pk_bf16_f32 v32, v232, v233
    v_cvt_pk_bf16_f32 v33, v234, v235
    v_cvt_pk_bf16_f32 v34, v236, v237
    v_cvt_pk_bf16_f32 v35, v238, v239
    v_dot2_f32_bf16 v232, v36, s70, v240
    v_dot2_f32_bf16 v233, v36, s71, v240
    v_dot2_f32_bf16 v234, v37, s70, v240
    v_dot2_f32_bf16 v235, v37, s71, v240
    v_dot2_f32_bf16 v236, v38, s70, v240
    v_dot2_f32_bf16 v237, v38, s71, v240
    v_dot2_f32_bf16 v238, v39, s70, v240
    v_dot2_f32_bf16 v239, v39, s71, v240
    v_cvt_pk_bf16_f32 v36, v232, v233
    s_add_u32 m0, s97, 135168
    s_nop 0
    buffer_load_dwordx4 v196, s[48:51], s3 offen lds
    v_cvt_pk_bf16_f32 v37, v234, v235
    v_cvt_pk_bf16_f32 v38, v236, v237
    v_cvt_pk_bf16_f32 v39, v238, v239
    v_dot2_f32_bf16 v232, v40, s70, v240
    v_dot2_f32_bf16 v233, v40, s71, v240
    v_dot2_f32_bf16 v234, v41, s70, v240
    v_dot2_f32_bf16 v235, v41, s71, v240
    v_dot2_f32_bf16 v236, v42, s70, v240
    v_dot2_f32_bf16 v237, v42, s71, v240
    v_dot2_f32_bf16 v238, v43, s70, v240
    v_dot2_f32_bf16 v239, v43, s71, v240
    v_cvt_pk_bf16_f32 v40, v232, v233
    v_cvt_pk_bf16_f32 v41, v234, v235
    v_cvt_pk_bf16_f32 v42, v236, v237
    s_mul_i32 s91, s84, 1792
    s_mul_i32 s92, s85, 1792
    s_mul_i32 s93, s86, 1792
    s_mul_i32 s94, s87, 1792
    s_mul_i32 s95, s88, 1792
    s_mul_i32 s96, s89, 1792
    s_mul_i32 s97, s90, 1792
    s_add_u32 m0, s100, 0
    s_nop 0
    buffer_load_dwordx4 v197, s[52:55], s91 offen offset:0 lds
    v_cvt_pk_bf16_f32 v43, v238, v239
    v_dot2_f32_bf16 v232, v44, s70, v240
    v_dot2_f32_bf16 v233, v44, s71, v240
    v_dot2_f32_bf16 v234, v45, s70, v240
    v_dot2_f32_bf16 v235, v45, s71, v240
    v_dot2_f32_bf16 v236, v46, s70, v240
    v_dot2_f32_bf16 v237, v46, s71, v240
    v_dot2_f32_bf16 v238, v47, s70, v240
    buffer_load_dwordx4 v198, s[52:55], s91 offen offset:1024 lds
    v_dot2_f32_bf16 v239, v47, s71, v240
    v_cvt_pk_bf16_f32 v44, v232, v233
    v_cvt_pk_bf16_f32 v45, v234, v235
    v_cvt_pk_bf16_f32 v46, v236, v237
    v_cvt_pk_bf16_f32 v47, v238, v239
    v_dot2_f32_bf16 v232, v48, s70, v240
    v_dot2_f32_bf16 v233, v48, s71, v240
    v_dot2_f32_bf16 v234, v49, s70, v240
    v_dot2_f32_bf16 v235, v49, s71, v240
    v_dot2_f32_bf16 v236, v50, s70, v240
    v_dot2_f32_bf16 v237, v50, s71, v240
    v_dot2_f32_bf16 v238, v51, s70, v240
    v_dot2_f32_bf16 v239, v51, s71, v240
    v_cvt_pk_bf16_f32 v48, v232, v233
    s_add_u32 m0, s100, 2048
    s_nop 0
    buffer_load_dwordx4 v197, s[52:55], s92 offen offset:0 lds
    v_cvt_pk_bf16_f32 v49, v234, v235
    v_cvt_pk_bf16_f32 v50, v236, v237
    v_cvt_pk_bf16_f32 v51, v238, v239
    v_dot2_f32_bf16 v232, v52, s70, v240
    v_dot2_f32_bf16 v233, v52, s71, v240
    v_dot2_f32_bf16 v234, v53, s70, v240
    v_dot2_f32_bf16 v235, v53, s71, v240
    v_dot2_f32_bf16 v236, v54, s70, v240
    v_dot2_f32_bf16 v237, v54, s71, v240
    v_dot2_f32_bf16 v238, v55, s70, v240
    v_dot2_f32_bf16 v239, v55, s71, v240
    v_cvt_pk_bf16_f32 v52, v232, v233
    v_cvt_pk_bf16_f32 v53, v234, v235
    v_cvt_pk_bf16_f32 v54, v236, v237
    buffer_load_dwordx4 v198, s[52:55], s92 offen offset:1024 lds
    v_cvt_pk_bf16_f32 v55, v238, v239
    v_dot2_f32_bf16 v232, v56, s70, v240
    v_dot2_f32_bf16 v233, v56, s71, v240
    v_dot2_f32_bf16 v234, v57, s70, v240
    v_dot2_f32_bf16 v235, v57, s71, v240
    v_dot2_f32_bf16 v236, v58, s70, v240
    v_dot2_f32_bf16 v237, v58, s71, v240
    v_dot2_f32_bf16 v238, v59, s70, v240
    v_dot2_f32_bf16 v239, v59, s71, v240
    v_cvt_pk_bf16_f32 v56, v232, v233
    v_cvt_pk_bf16_f32 v57, v234, v235
    v_cvt_pk_bf16_f32 v58, v236, v237
    v_cvt_pk_bf16_f32 v59, v238, v239
    v_dot2_f32_bf16 v232, v60, s70, v240
    v_dot2_f32_bf16 v233, v60, s71, v240
    s_add_u32 m0, s100, 4096
    s_nop 0
    buffer_load_dwordx4 v197, s[52:55], s93 offen offset:0 lds
    v_dot2_f32_bf16 v234, v61, s70, v240
    v_dot2_f32_bf16 v235, v61, s71, v240
    v_dot2_f32_bf16 v236, v62, s70, v240
    v_dot2_f32_bf16 v237, v62, s71, v240
    v_dot2_f32_bf16 v238, v63, s70, v240
    v_dot2_f32_bf16 v239, v63, s71, v240
    v_cvt_pk_bf16_f32 v60, v232, v233
    v_cvt_pk_bf16_f32 v61, v234, v235
    v_cvt_pk_bf16_f32 v62, v236, v237
    v_cvt_pk_bf16_f32 v63, v238, v239
    v_dot2_f32_bf16 v232, v64, s70, v240
    v_dot2_f32_bf16 v233, v64, s71, v240
    v_dot2_f32_bf16 v234, v65, s70, v240
    v_dot2_f32_bf16 v235, v65, s71, v240
    buffer_load_dwordx4 v198, s[52:55], s93 offen offset:1024 lds
    v_dot2_f32_bf16 v236, v66, s70, v240
    v_dot2_f32_bf16 v237, v66, s71, v240
    v_dot2_f32_bf16 v238, v67, s70, v240
    v_dot2_f32_bf16 v239, v67, s71, v240
    v_cvt_pk_bf16_f32 v64, v232, v233
    v_cvt_pk_bf16_f32 v65, v234, v235
    v_cvt_pk_bf16_f32 v66, v236, v237
    v_cvt_pk_bf16_f32 v67, v238, v239
    v_dot2_f32_bf16 v232, v68, s70, v240
    v_dot2_f32_bf16 v233, v68, s71, v240
    v_dot2_f32_bf16 v234, v69, s70, v240
    v_dot2_f32_bf16 v235, v69, s71, v240
    v_dot2_f32_bf16 v236, v70, s70, v240
    v_dot2_f32_bf16 v237, v70, s71, v240
    v_dot2_f32_bf16 v238, v71, s70, v240
    s_add_u32 m0, s100, 6144
    s_nop 0
    buffer_load_dwordx4 v197, s[52:55], s94 offen offset:0 lds
    v_dot2_f32_bf16 v239, v71, s71, v240
    v_cvt_pk_bf16_f32 v68, v232, v233
    v_cvt_pk_bf16_f32 v69, v234, v235
    v_cvt_pk_bf16_f32 v70, v236, v237
    v_cvt_pk_bf16_f32 v71, v238, v239
    v_dot2_f32_bf16 v232, v72, s70, v240
    v_dot2_f32_bf16 v233, v72, s71, v240
    v_dot2_f32_bf16 v234, v73, s70, v240
    v_dot2_f32_bf16 v235, v73, s71, v240
    v_dot2_f32_bf16 v236, v74, s70, v240
    v_dot2_f32_bf16 v237, v74, s71, v240
    v_dot2_f32_bf16 v238, v75, s70, v240
    v_dot2_f32_bf16 v239, v75, s71, v240
    v_cvt_pk_bf16_f32 v72, v232, v233
    buffer_load_dwordx4 v198, s[52:55], s94 offen offset:1024 lds
    v_cvt_pk_bf16_f32 v73, v234, v235
    v_cvt_pk_bf16_f32 v74, v236, v237
    v_cvt_pk_bf16_f32 v75, v238, v239
    v_dot2_f32_bf16 v232, v76, s70, v240
    v_dot2_f32_bf16 v233, v76, s71, v240
    v_dot2_f32_bf16 v234, v77, s70, v240
    v_dot2_f32_bf16 v235, v77, s71, v240
    v_dot2_f32_bf16 v236, v78, s70, v240
    v_dot2_f32_bf16 v237, v78, s71, v240
    v_dot2_f32_bf16 v238, v79, s70, v240
    v_dot2_f32_bf16 v239, v79, s71, v240
    v_cvt_pk_bf16_f32 v76, v232, v233
    v_cvt_pk_bf16_f32 v77, v234, v235
    v_cvt_pk_bf16_f32 v78, v236, v237
    s_add_u32 m0, s100, 8192
    s_nop 0
    buffer_load_dwordx4 v197, s[52:55], s95 offen offset:0 lds
    v_cvt_pk_bf16_f32 v79, v238, v239
    buffer_load_dwordx2 v[250:251], v252, s[56:59], 0 offen offset:0 sc1
    v_dot2_f32_bf16 v232, v80, s70, v240
    v_dot2_f32_bf16 v233, v80, s71, v240
    v_dot2_f32_bf16 v234, v81, s70, v240
    v_dot2_f32_bf16 v235, v81, s71, v240
    v_dot2_f32_bf16 v236, v82, s70, v240
    v_dot2_f32_bf16 v237, v82, s71, v240
    v_dot2_f32_bf16 v238, v83, s70, v240
    v_dot2_f32_bf16 v239, v83, s71, v240
    v_cvt_pk_bf16_f32 v80, v232, v233
    v_cvt_pk_bf16_f32 v81, v234, v235
    v_cvt_pk_bf16_f32 v82, v236, v237
    buffer_load_dwordx4 v198, s[52:55], s95 offen offset:1024 lds
    v_cvt_pk_bf16_f32 v83, v238, v239
    v_dot2_f32_bf16 v232, v84, s70, v240
    v_dot2_f32_bf16 v233, v84, s71, v240
    v_dot2_f32_bf16 v234, v85, s70, v240
    v_dot2_f32_bf16 v235, v85, s71, v240
    v_dot2_f32_bf16 v236, v86, s70, v240
    v_dot2_f32_bf16 v237, v86, s71, v240
    v_dot2_f32_bf16 v238, v87, s70, v240
    v_dot2_f32_bf16 v239, v87, s71, v240
    v_cvt_pk_bf16_f32 v84, v232, v233
    v_cvt_pk_bf16_f32 v85, v234, v235
    v_cvt_pk_bf16_f32 v86, v236, v237
    v_cvt_pk_bf16_f32 v87, v238, v239
    v_dot2_f32_bf16 v232, v88, s70, v240
    v_dot2_f32_bf16 v233, v88, s71, v240
    s_add_u32 m0, s100, 10240
    s_nop 0
    buffer_load_dwordx4 v197, s[52:55], s96 offen offset:0 lds
    v_dot2_f32_bf16 v234, v89, s70, v240
    v_dot2_f32_bf16 v235, v89, s71, v240
    v_dot2_f32_bf16 v236, v90, s70, v240
    v_dot2_f32_bf16 v237, v90, s71, v240
    v_dot2_f32_bf16 v238, v91, s70, v240
    v_dot2_f32_bf16 v239, v91, s71, v240
    v_cvt_pk_bf16_f32 v88, v232, v233
    v_cvt_pk_bf16_f32 v89, v234, v235
    v_cvt_pk_bf16_f32 v90, v236, v237
    v_cvt_pk_bf16_f32 v91, v238, v239
    v_dot2_f32_bf16 v232, v92, s70, v240
    v_dot2_f32_bf16 v233, v92, s71, v240
    v_dot2_f32_bf16 v234, v93, s70, v240
    v_dot2_f32_bf16 v235, v93, s71, v240
    buffer_load_dwordx4 v198, s[52:55], s96 offen offset:1024 lds
    v_dot2_f32_bf16 v236, v94, s70, v240
    v_dot2_f32_bf16 v237, v94, s71, v240
    v_dot2_f32_bf16 v238, v95, s70, v240
    v_dot2_f32_bf16 v239, v95, s71, v240
    v_cvt_pk_bf16_f32 v92, v232, v233
    v_cvt_pk_bf16_f32 v93, v234, v235
    v_cvt_pk_bf16_f32 v94, v236, v237
    v_cvt_pk_bf16_f32 v95, v238, v239
    v_dot2_f32_bf16 v232, v96, s70, v240
    v_dot2_f32_bf16 v233, v96, s71, v240
    v_dot2_f32_bf16 v234, v97, s70, v240
    v_dot2_f32_bf16 v235, v97, s71, v240
    v_dot2_f32_bf16 v236, v98, s70, v240
    v_dot2_f32_bf16 v237, v98, s71, v240
    v_dot2_f32_bf16 v238, v99, s70, v240
    s_add_u32 m0, s100, 12288
    s_nop 0
    buffer_load_dwordx4 v197, s[52:55], s97 offen offset:0 lds
    v_dot2_f32_bf16 v239, v99, s71, v240
    v_cvt_pk_bf16_f32 v96, v232, v233
    v_cvt_pk_bf16_f32 v97, v234, v235
    v_cvt_pk_bf16_f32 v98, v236, v237
    v_cvt_pk_bf16_f32 v99, v238, v239
    v_dot2_f32_bf16 v232, v100, s70, v240
    v_dot2_f32_bf16 v233, v100, s71, v240
    v_dot2_f32_bf16 v234, v101, s70, v240
    v_dot2_f32_bf16 v235, v101, s71, v240
    v_dot2_f32_bf16 v236, v102, s70, v240
    v_dot2_f32_bf16 v237, v102, s71, v240
    v_dot2_f32_bf16 v238, v103, s70, v240
    v_dot2_f32_bf16 v239, v103, s71, v240
    v_cvt_pk_bf16_f32 v100, v232, v233
    buffer_load_dwordx4 v198, s[52:55], s97 offen offset:1024 lds
    v_cvt_pk_bf16_f32 v101, v234, v235
    v_cvt_pk_bf16_f32 v102, v236, v237
    v_cvt_pk_bf16_f32 v103, v238, v239
    s_waitcnt vmcnt(15)
    s_barrier
    ds_read_b128 a[224:227], v199 offset:0
    ds_read_b128 a[228:231], v199 offset:28672
    ds_read_b128 a[232:235], v200 offset:0
    ds_read_b128 a[236:239], v200 offset:28672
    ds_read_b128 a[240:243], v201 offset:0
    ds_read_b128 a[244:247], v201 offset:28672
    s_waitcnt lgkmcnt(4)
    v_mfma_f32_32x32x16_bf16 v[128:143], v[16:19], a[224:227], 0
    ds_read_b128 a[248:251], v202 offset:0
    v_lshlrev_b32 v232, 16, v104
    v_and_b32 v233, s15, v104
    s_add_u32 m0, s100, 14208
    s_nop 0
    buffer_load_dwordx4 v197, s[52:55], s91 offen offset:128 lds
    v_sub_f32 v232, v232, v7
    v_mfma_f32_32x32x16_bf16 v[144:159], v[16:19], a[228:231], 0
    ds_read_b128 a[252:255], v202 offset:28672
    v_sub_f32 v233, v233, v7
    v_cvt_pk_bf16_f32 v104, v232, v233
    v_lshlrev_b32 v234, 16, v105
    s_waitcnt lgkmcnt(4)
    v_mfma_f32_32x32x16_bf16 v[128:143], v[20:23], a[232:235], v[128:143]
    ds_read_b128 a[224:227], v199 offset:4096
    v_and_b32 v235, s15, v105
    v_sub_f32 v234, v234, v7
    v_sub_f32 v235, v235, v7
    buffer_load_dwordx4 v198, s[52:55], s91 offen offset:1152 lds
    v_mfma_f32_32x32x16_bf16 v[144:159], v[20:23], a[236:239], v[144:159]
    ds_read_b128 a[228:231], v199 offset:32768
    v_cvt_pk_bf16_f32 v105, v234, v235
    v_lshlrev_b32 v232, 16, v106
    v_and_b32 v233, s15, v106
    s_waitcnt lgkmcnt(4)
    v_mfma_f32_32x32x16_bf16 v[128:143], v[24:27], a[240:243], v[128:143]
    ds_read_b128 a[232:235], v200 offset:4096
    v_sub_f32 v232, v232, v7
    v_sub_f32 v233, v233, v7
    v_cvt_pk_bf16_f32 v106, v232, v233
    v_lshlrev_b32 v234, 16, v107
    s_add_u32 m0, s100, 16256
    s_nop 0
    buffer_load_dwordx4 v197, s[52:55], s92 offen offset:128 lds
    v_mfma_f32_32x32x16_bf16 v[144:159], v[24:27], a[244:247], v[144:159]
    ds_read_b128 a[236:239], v200 offset:32768
    v_and_b32 v235, s15, v107
    v_sub_f32 v234, v234, v7
    v_sub_f32 v235, v235, v7
    s_waitcnt lgkmcnt(4)
    v_mfma_f32_32x32x16_bf16 v[128:143], v[28:31], a[248:251], v[128:143]
    ds_read_b128 a[240:243], v201 offset:4096
    v_cvt_pk_bf16_f32 v107, v234, v235
    v_lshlrev_b32 v232, 16, v108
    v_and_b32 v233, s15, v108
    v_mfma_f32_32x32x16_bf16 v[144:159], v[28:31], a[252:255], v[144:159]
    buffer_load_dwordx4 v198, s[52:55], s92 offen offset:1152 lds
    ds_read_b128 a[244:247], v201 offset:32768
    v_sub_f32 v232, v232, v7
    v_sub_f32 v233, v233, v7
    v_cvt_pk_bf16_f32 v108, v232, v233
    s_waitcnt lgkmcnt(4)
    v_mfma_f32_32x32x16_bf16 v[128:143], v[32:35], a[224:227], v[128:143]
    ds_read_b128 a[248:251], v202 offset:4096
    v_lshlrev_b32 v234, 16, v109
    v_and_b32 v235, s15, v109
    v_sub_f32 v234, v234, v7
    v_sub_f32 v235, v235, v7
    v_mfma_f32_32x32x16_bf16 v[144:159], v[32:35], a[228:231], v[144:159]
    s_add_u32 m0, s100, 18304
    s_nop 0
    buffer_load_dwordx4 v197, s[52:55], s93 offen offset:128 lds
    ds_read_b128 a[252:255], v202 offset:32768
    v_cvt_pk_bf16_f32 v109, v234, v235
    v_lshlrev_b32 v232, 16, v110
    v_and_b32 v233, s15, v110
    s_waitcnt lgkmcnt(4)
    v_mfma_f32_32x32x16_bf16 v[128:143], v[36:39], a[232:235], v[128:143]
    ds_read_b128 a[224:227], v199 offset:8192
    v_sub_f32 v232, v232, v7
    v_sub_f32 v233, v233, v7
    v_cvt_pk_bf16_f32 v110, v232, v233
    v_mfma_f32_32x32x16_bf16 v[144:159], v[36:39], a[236:239], v[144:159]
    buffer_load_dwordx4 v198, s[52:55], s93 offen offset:1152 lds
    ds_read_b128 a[228:231], v199 offset:36864
    v_lshlrev_b32 v234, 16, v111
    v_and_b32 v235, s15, v111
    v_sub_f32 v234, v234, v7
    s_waitcnt lgkmcnt(4)
    v_mfma_f32_32x32x16_bf16 v[128:143], v[40:43], a[240:243], v[128:143]
    ds_read_b128 a[232:235], v200 offset:8192
    v_sub_f32 v235, v235, v7
    v_cvt_pk_bf16_f32 v111, v234, v235
    v_lshlrev_b32 v232, 16, v112
    v_mfma_f32_32x32x16_bf16 v[144:159], v[40:43], a[244:247], v[144:159]
    ds_read_b128 a[236:239], v200 offset:36864
    v_and_b32 v233, s15, v112
    s_add_u32 m0, s100, 20352
    s_nop 0
    buffer_load_dwordx4 v197, s[52:55], s94 offen offset:128 lds
    v_sub_f32 v232, v232, v7
    v_sub_f32 v233, v233, v7
    v_cvt_pk_bf16_f32 v112, v232, v233
    s_waitcnt lgkmcnt(4)
    v_mfma_f32_32x32x16_bf16 v[128:143], v[44:47], a[248:251], v[128:143]
    ds_read_b128 a[240:243], v201 offset:8192
    v_lshlrev_b32 v234, 16, v113
    v_and_b32 v235, s15, v113
    v_sub_f32 v234, v234, v7
    v_mfma_f32_32x32x16_bf16 v[144:159], v[44:47], a[252:255], v[144:159]
    ds_read_b128 a[244:247], v201 offset:36864
    v_sub_f32 v235, v235, v7
    buffer_load_dwordx4 v198, s[52:55], s94 offen offset:1152 lds
    v_cvt_pk_bf16_f32 v113, v234, v235
    v_lshlrev_b32 v232, 16, v114
    s_waitcnt lgkmcnt(4)
    v_mfma_f32_32x32x16_bf16 v[128:143], v[48:51], a[224:227], v[128:143]
    ds_read_b128 a[248:251], v202 offset:8192
    v_and_b32 v233, s15, v114
    v_sub_f32 v232, v232, v7
    v_sub_f32 v233, v233, v7
    v_mfma_f32_32x32x16_bf16 v[144:159], v[48:51], a[228:231], v[144:159]
    ds_read_b128 a[252:255], v202 offset:36864
    v_cvt_pk_bf16_f32 v114, v232, v233
    v_lshlrev_b32 v234, 16, v115
    s_add_u32 m0, s100, 22400
    s_nop 0
    buffer_load_dwordx4 v197, s[52:55], s95 offen offset:128 lds
    v_and_b32 v235, s15, v115
    v_sub_f32 v234, v234, v7
    s_waitcnt lgkmcnt(4)
    v_mfma_f32_32x32x16_bf16 v[128:143], v[52:55], a[232:235], v[128:143]
    ds_read_b128 a[224:227], v199 offset:12288
    v_sub_f32 v235, v235, v7
    v_cvt_pk_bf16_f32 v115, v234, v235
    v_lshlrev_b32 v232, 16, v116
    v_mfma_f32_32x32x16_bf16 v[144:159], v[52:55], a[236:239], v[144:159]
    ds_read_b128 a[228:231], v199 offset:40960
    v_and_b32 v233, s15, v116
    v_sub_f32 v232, v232, v7
    buffer_load_dwordx4 v198, s[52:55], s95 offen offset:1152 lds
    v_sub_f32 v233, v233, v7
    s_waitcnt lgkmcnt(4)
    v_mfma_f32_32x32x16_bf16 v[128:143], v[56:59], a[240:243], v[128:143]
    ds_read_b128 a[232:235], v200 offset:12288
    v_cvt_pk_bf16_f32 v116, v232, v233
    v_lshlrev_b32 v234, 16, v117
    v_and_b32 v235, s15, v117
    v_mfma_f32_32x32x16_bf16 v[144:159], v[56:59], a[244:247], v[144:159]
    ds_read_b128 a[236:239], v200 offset:40960
    v_sub_f32 v234, v234, v7
    v_sub_f32 v235, v235, v7
    v_cvt_pk_bf16_f32 v117, v234, v235
    s_waitcnt lgkmcnt(4)
    v_mfma_f32_32x32x16_bf16 v[128:143], v[60:63], a[248:251], v[128:143]
    s_waitcnt vmcnt(15)
    v_cmp_ne_u32 vcc, s12, v250
    v_cmp_ne_u32 s[30:31], s13, v251
    s_nop 1
    s_or_b32 s37, vcc_lo, s30
    s_and_b32 s37, s37, s69
    s_cbranch_scc1 L_retry_p0
L_ok_p0:
    ds_read_b128 a[240:243], v201 offset:12288
    s_add_u32 s28, s21, 0
    buffer_load_dwordx4 a[0:3], v2, s[56:59], s28 offen offset:0 sc1
    v_lshlrev_b32 v232, 16, v118
    v_and_b32 v233, s15, v118
    v_sub_f32 v232, v232, v7
    v_sub_f32 v233, v233, v7
    v_mfma_f32_32x32x16_bf16 v[144:159], v[60:63], a[252:255], v[144:159]
    ds_read_b128 a[244:247], v201 offset:40960
    v_cvt_pk_bf16_f32 v118, v232, v233
    v_lshlrev_b32 v234, 16, v119
    v_and_b32 v235, s15, v119
    s_waitcnt lgkmcnt(4)
    v_mfma_f32_32x32x16_bf16 v[128:143], v[64:67], a[224:227], v[128:143]
    buffer_load_dwordx4 a[4:7], v2, s[56:59], s28 offen offset:1024 sc1
    ds_read_b128 a[248:251], v202 offset:12288
    v_sub_f32 v234, v234, v7
    v_sub_f32 v235, v235, v7
    v_cvt_pk_bf16_f32 v119, v234, v235
    v_mfma_f32_32x32x16_bf16 v[144:159], v[64:67], a[228:231], v[144:159]
    ds_read_b128 a[252:255], v202 offset:40960
    v_lshlrev_b32 v232, 16, v120
    v_and_b32 v233, s15, v120
    v_sub_f32 v232, v232, v7
    s_waitcnt lgkmcnt(4)
    v_mfma_f32_32x32x16_bf16 v[128:143], v[68:71], a[232:235], v[128:143]
    ds_read_b128 a[224:227], v199 offset:16384
    buffer_load_dwordx4 a[8:11], v2, s[56:59], s28 offen offset:2048 sc1
    v_sub_f32 v233, v233, v7
    v_cvt_pk_bf16_f32 v120, v232, v233
    v_lshlrev_b32 v234, 16, v121
    v_and_b32 v235, s15, v121
    v_mfma_f32_32x32x16_bf16 v[144:159], v[68:71], a[236:239], v[144:159]
    ds_read_b128 a[228:231], v199 offset:45056
    v_sub_f32 v234, v234, v7
    v_sub_f32 v235, v235, v7
    v_cvt_pk_bf16_f32 v121, v234, v235
    s_waitcnt lgkmcnt(4)
    v_mfma_f32_32x32x16_bf16 v[128:143], v[72:75], a[240:243], v[128:143]
    ds_read_b128 a[232:235], v200 offset:16384
    buffer_load_dwordx4 a[12:15], v2, s[56:59], s28 offen offset:3072 sc1
    v_lshlrev_b32 v232, 16, v122
    v_and_b32 v233, s15, v122
    v_sub_f32 v232, v232, v7
    v_mfma_f32_32x32x16_bf16 v[144:159], v[72:75], a[244:247], v[144:159]
    ds_read_b128 a[236:239], v200 offset:45056
    v_sub_f32 v233, v233, v7
    v_cvt_pk_bf16_f32 v122, v232, v233
    v_lshlrev_b32 v234, 16, v123
    s_waitcnt lgkmcnt(4)
    v_mfma_f32_32x32x16_bf16 v[128:143], v[76:79], a[248:251], v[128:143]
    ds_read_b128 a[240:243], v201 offset:16384
    v_and_b32 v235, s15, v123
    v_sub_f32 v234, v234, v7
    s_add_u32 s28, s21, 4096
    buffer_load_dwordx4 a[16:19], v2, s[56:59], s28 offen offset:0 sc1
    v_sub_f32 v235, v235, v7
    v_mfma_f32_32x32x16_bf16 v[144:159], v[76:79], a[252:255], v[144:159]
    ds_read_b128 a[244:247], v201 offset:45056
    v_cvt_pk_bf16_f32 v123, v234, v235
    v_lshlrev_b32 v232, 16, v124
    v_and_b32 v233, s15, v124
    v_sub_f32 v232, v232, v7
    s_waitcnt lgkmcnt(4)
    v_mfma_f32_32x32x16_bf16 v[128:143], v[80:83], a[224:227], v[128:143]
    ds_read_b128 a[248:251], v202 offset:16384
    v_sub_f32 v233, v233, v7
    v_cvt_pk_bf16_f32 v124, v232, v233
    buffer_load_dwordx4 a[20:23], v2, s[56:59], s28 offen offset:1024 sc1
    v_lshlrev_b32 v234, 16, v125
    v_mfma_f32_32x32x16_bf16 v[144:159], v[80:83], a[228:231], v[144:159]
    ds_read_b128 a[252:255], v202 offset:45056
    v_and_b32 v235, s15, v125
    v_sub_f32 v234, v234, v7
    v_sub_f32 v235, v235, v7
    s_waitcnt lgkmcnt(4)
    v_mfma_f32_32x32x16_bf16 v[128:143], v[84:87], a[232:235], v[128:143]
    ds_read_b128 a[224:227], v199 offset:20480
    v_cvt_pk_bf16_f32 v125, v234, v235
    v_lshlrev_b32 v232, 16, v126
    v_and_b32 v233, s15, v126
    buffer_load_dwordx4 a[24:27], v2, s[56:59], s28 offen offset:2048 sc1
    v_mfma_f32_32x32x16_bf16 v[144:159], v[84:87], a[236:239], v[144:159]
    ds_read_b128 a[228:231], v199 offset:49152
    v_sub_f32 v232, v232, v7
    v_sub_f32 v233, v233, v7
    v_cvt_pk_bf16_f32 v126, v232, v233
    v_lshlrev_b32 v234, 16, v127
    s_waitcnt lgkmcnt(4)
    v_mfma_f32_32x32x16_bf16 v[128:143], v[88:91], a[240:243], v[128:143]
    ds_read_b128 a[232:235], v200 offset:20480
    v_and_b32 v235, s15, v127
    v_sub_f32 v234, v234, v7
    v_sub_f32 v235, v235, v7
    v_mfma_f32_32x32x16_bf16 v[144:159], v[88:91], a[244:247], v[144:159]
    buffer_load_dwordx4 a[28:31], v2, s[56:59], s28 offen offset:3072 sc1
    ds_read_b128 a[236:239], v200 offset:49152
    v_cvt_pk_bf16_f32 v127, v234, v235
    v_lshlrev_b32 v224, 16, v224
    v_lshlrev_b32 v225, 16, v225
    s_waitcnt lgkmcnt(4)
    v_mfma_f32_32x32x16_bf16 v[128:143], v[92:95], a[248:251], v[128:143]
    ds_read_b128 a[240:243], v201 offset:20480
    v_lshlrev_b32 v226, 16, v226
    v_mul_f32 v226, 0x3fb8aa3b, v226
    v_exp_f32 v226, v226
    v_mfma_f32_32x32x16_bf16 v[144:159], v[92:95], a[252:255], v[144:159]
    s_add_u32 s28, s21, 8192
    buffer_load_dwordx4 a[32:35], v2, s[56:59], s28 offen offset:0 sc1
    ds_read_b128 a[244:247], v201 offset:49152
    v_cvt_pk_bf16_f32 v226, v226, v226
    v_lshlrev_b32 v226, 16, v226
    v_mul_f32 v184, v226, v224
    s_waitcnt lgkmcnt(4)
    v_mfma_f32_32x32x16_bf16 v[128:143], v[96:99], a[224:227], v[128:143]
    ds_read_b128 a[248:251], v202 offset:20480
    v_mul_f32 v185, v226, v225
    v_mul_f32 v184, 0x3fb8aa3b, v184
    v_exp_f32 v184, v184
    v_mul_f32 v185, 0x3e22f983, v185
    v_mfma_f32_32x32x16_bf16 v[144:159], v[96:99], a[228:231], v[144:159]
    buffer_load_dwordx4 a[36:39], v2, s[56:59], s28 offen offset:1024 sc1
    ds_read_b128 a[252:255], v202 offset:49152
    v_fract_f32 v185, v185
    v_cos_f32 v207, v185
    v_sin_f32 v208, v185
    s_waitcnt lgkmcnt(4)
    v_mfma_f32_32x32x16_bf16 v[128:143], v[100:103], a[232:235], v[128:143]
    ds_read_b128 a[224:227], v199 offset:24576
    v_mul_f32 v207, v184, v207
    v_mul_f32 v208, v184, v208
    v_sub_f32 v209, 0, v208
    v_mfma_f32_32x32x16_bf16 v[144:159], v[100:103], a[236:239], v[144:159]
    buffer_load_dwordx4 a[40:43], v2, s[56:59], s28 offen offset:2048 sc1
    ds_read_b128 a[228:231], v199 offset:53248
    v_mul_f32 v210, v207, v207
    v_mul_f32 v211, v207, v208
    v_fma_f32 v210, -v208, v208, v210
    s_waitcnt lgkmcnt(4)
    v_mfma_f32_32x32x16_bf16 v[128:143], v[104:107], a[240:243], v[128:143]
    ds_read_b128 a[232:235], v200 offset:24576
    v_fmac_f32 v211, v208, v207
    v_mul_f32 v212, v210, v207
    v_mul_f32 v213, v210, v208
    v_fma_f32 v212, -v211, v208, v212
    v_mfma_f32_32x32x16_bf16 v[144:159], v[104:107], a[244:247], v[144:159]
    buffer_load_dwordx4 a[44:47], v2, s[56:59], s28 offen offset:3072 sc1
    ds_read_b128 a[236:239], v200 offset:53248
    v_fmac_f32 v213, v211, v207
    v_mul_f32 v214, v210, v210
    v_mul_f32 v215, v210, v211
    s_waitcnt lgkmcnt(4)
    v_mfma_f32_32x32x16_bf16 v[128:143], v[108:111], a[248:251], v[128:143]
    ds_read_b128 a[240:243], v201 offset:24576
    v_fma_f32 v214, -v211, v211, v214
    v_fmac_f32 v215, v211, v210
    v_mul_f32 v184, v214, v214
    v_mfma_f32_32x32x16_bf16 v[144:159], v[108:111], a[252:255], v[144:159]
    ds_read_b128 a[244:247], v201 offset:53248
    s_add_u32 s28, s21, 12288
    buffer_load_dwordx4 a[48:51], v2, s[56:59], s28 offen offset:0 sc1
    v_mul_f32 v185, v214, v215
    v_fma_f32 v184, -v215, v215, v184
    v_fmac_f32 v185, v215, v214
    s_waitcnt lgkmcnt(4)
    v_mfma_f32_32x32x16_bf16 v[128:143], v[112:115], a[224:227], v[128:143]
    ds_read_b128 a[248:251], v202 offset:24576
    v_mul_f32 v186, v184, v184
    v_mul_f32 v187, v184, v185
    v_fma_f32 v186, -v185, v185, v186
    v_mfma_f32_32x32x16_bf16 v[144:159], v[112:115], a[228:231], v[144:159]
    ds_read_b128 a[252:255], v202 offset:53248
    buffer_load_dwordx4 a[52:55], v2, s[56:59], s28 offen offset:1024 sc1
    v_fmac_f32 v187, v185, v184
    v_mul_f32 v216, v186, v186
    v_mul_f32 v217, v186, v187
    v_fma_f32 v216, -v187, v187, v216
    s_waitcnt lgkmcnt(4)
    v_mfma_f32_32x32x16_bf16 v[128:143], v[116:119], a[232:235], v[128:143]
    v_fmac_f32 v217, v187, v186
    v_mul_f32 v184, v216, v216
    v_mul_f32 v185, v216, v217
    v_mfma_f32_32x32x16_bf16 v[144:159], v[116:119], a[236:239], v[144:159]
    v_fma_f32 v184, -v217, v217, v184
    s_add_u32 s28, s21, 57344
    buffer_load_dwordx4 a[56:59], v2, s[56:59], s28 offen offset:0 sc1
    v_fmac_f32 v185, v217, v216
    v_mul_f32 v218, v184, v184
    s_waitcnt lgkmcnt(2)
    v_mfma_f32_32x32x16_bf16 v[128:143], v[120:123], a[240:243], v[128:143]
    v_mul_f32 v219, v184, v185
    v_fma_f32 v218, -v185, v185, v218
    v_fmac_f32 v219, v185, v184
    v_mfma_f32_32x32x16_bf16 v[144:159], v[120:123], a[244:247], v[144:159]
    v_mul_f32 v220, v218, v218
    v_mul_f32 v221, v218, v219
    v_fma_f32 v220, -v219, v219, v220
    buffer_load_dwordx4 a[60:63], v2, s[56:59], s28 offen offset:1024 sc1
    v_fmac_f32 v221, v219, v218
    s_waitcnt lgkmcnt(0)
    v_mfma_f32_32x32x16_bf16 v[128:143], v[124:127], a[248:251], v[128:143]
    v_mfma_f32_32x32x16_bf16 v[144:159], v[124:127], a[252:255], v[144:159]
    v_lshl_add_u32 v3, v12, 4, s26
    ds_read_b128 v[232:235], v3 offset:0
    ds_read_b128 v[236:239], v3 offset:32
    ds_read_b128 v[240:243], v3 offset:64
    buffer_load_dwordx4 a[64:67], v2, s[56:59], s28 offen offset:2048 sc1
    ds_read_b128 v[244:247], v3 offset:96
    s_waitcnt vmcnt(27)
    s_waitcnt lgkmcnt(0)
    s_barrier
    s_lshl_b32 s27, s9, 13
    s_add_u32 s27, s27, 65536
    s_add_u32 s44, s6, s27
    s_addc_u32 s45, s7, 0
    s_mov_b32 s46, 8192
    s_mov_b32 s47, 0x20000
    s_lshl_b32 s101, s10, 12
    ds_read_b64_tr_b16 a[224:225], v203 offset:0
    ds_read_b64_tr_b16 a[226:227], v203 offset:512
    ds_read_b64_tr_b16 a[228:229], v203 offset:24576
    ds_read_b64_tr_b16 a[230:231], v203 offset:25088
    ds_read_b64_tr_b16 a[232:233], v203 offset:49152
    ds_read_b64_tr_b16 a[234:235], v203 offset:49664
    ds_read_b64_tr_b16 a[236:237], v204 offset:8192
    ds_read_b64_tr_b16 a[238:239], v204 offset:8704
    ds_read_b64_tr_b16 a[240:241], v203 offset:2048
    ds_read_b64_tr_b16 a[242:243], v203 offset:2560
    ds_read_b64_tr_b16 a[244:245], v203 offset:26624
    ds_read_b64_tr_b16 a[246:247], v203 offset:27136
    s_waitcnt lgkmcnt(8)
    v_mfma_f32_32x32x16_bf16 v[160:175], a[224:227], v[16:19], 0
    s_add_u32 m0, s101, 106368
    s_nop 0
    buffer_load_dwordx4 v197, s[52:55], s96 offen offset:128 lds
    ds_read_b64_tr_b16 a[248:249], v203 offset:51200
    ds_read_b64_tr_b16 a[250:251], v203 offset:51712
    v_mfma_f32_32x32x16_bf16 v[160:175], a[228:231], v[20:23], v[160:175]
    ds_read_b64_tr_b16 a[252:253], v204 offset:10240
    ds_read_b64_tr_b16 a[254:255], v204 offset:10752
    s_waitcnt lgkmcnt(8)
    v_mfma_f32_32x32x16_bf16 v[160:175], a[232:235], v[24:27], v[160:175]
    buffer_load_dwordx4 v198, s[52:55], s96 offen offset:1152 lds
    ds_read_b64_tr_b16 a[224:225], v203 offset:4096
    ds_read_b64_tr_b16 a[226:227], v203 offset:4608
    v_mul_f32 v128, v232, v128
    v_mul_f32 v144, v232, v144
    v_mul_f32 v129, v233, v129
    v_mul_f32 v145, v233, v145
    v_mul_f32 v130, v234, v130
    v_mfma_f32_32x32x16_bf16 v[160:175], a[236:239], v[28:31], v[160:175]
    ds_read_b64_tr_b16 a[228:229], v203 offset:28672
    ds_read_b64_tr_b16 a[230:231], v203 offset:29184
    v_mul_f32 v146, v234, v146
    v_mul_f32 v131, v235, v131
    v_mul_f32 v147, v235, v147
    v_mul_f32 v132, v236, v132
    v_mul_f32 v148, v236, v148
    s_add_u32 m0, s101, 108416
    s_nop 0
    buffer_load_dwordx4 v197, s[52:55], s97 offen offset:128 lds
    s_waitcnt lgkmcnt(8)
    v_mfma_f32_32x32x16_bf16 v[160:175], a[240:243], v[32:35], v[160:175]
    ds_read_b64_tr_b16 a[232:233], v203 offset:53248
    ds_read_b64_tr_b16 a[234:235], v203 offset:53760
    v_mul_f32 v133, v237, v133
    v_mul_f32 v149, v237, v149
    v_mul_f32 v134, v238, v134
    v_mul_f32 v150, v238, v150
    v_mul_f32 v135, v239, v135
    v_mfma_f32_32x32x16_bf16 v[160:175], a[244:247], v[36:39], v[160:175]
    ds_read_b64_tr_b16 a[236:237], v204 offset:12288
    ds_read_b64_tr_b16 a[238:239], v204 offset:12800
    v_mul_f32 v151, v239, v151
    v_mul_f32 v136, v240, v136
    buffer_load_dwordx4 v198, s[52:55], s97 offen offset:1152 lds
    v_mul_f32 v152, v240, v152
    v_mul_f32 v137, v241, v137
    v_mul_f32 v153, v241, v153
    s_waitcnt lgkmcnt(8)
    v_mfma_f32_32x32x16_bf16 v[160:175], a[248:251], v[40:43], v[160:175]
    ds_read_b64_tr_b16 a[240:241], v203 offset:6144
    ds_read_b64_tr_b16 a[242:243], v203 offset:6656
    v_mul_f32 v138, v242, v138
    v_mul_f32 v154, v242, v154
    v_mul_f32 v139, v243, v139
    v_mul_f32 v155, v243, v155
    v_mul_f32 v140, v244, v140
    v_mfma_f32_32x32x16_bf16 v[160:175], a[252:255], v[44:47], v[160:175]
    ds_read_b64_tr_b16 a[244:245], v203 offset:30720
    ds_read_b64_tr_b16 a[246:247], v203 offset:31232
    buffer_load_dwordx4 a[68:71], v2, s[56:59], s28 offen offset:3072 sc1
    v_mul_f32 v156, v244, v156
    v_mul_f32 v141, v245, v141
    v_mul_f32 v157, v245, v157
    v_mul_f32 v142, v246, v142
    v_mul_f32 v158, v246, v158
    v_mul_f32 v143, v247, v143
    s_waitcnt lgkmcnt(8)
    v_mfma_f32_32x32x16_bf16 v[160:175], a[224:227], v[48:51], v[160:175]
    ds_read_b64_tr_b16 a[248:249], v203 offset:55296
    ds_read_b64_tr_b16 a[250:251], v203 offset:55808
    v_mul_f32 v159, v247, v159
    v_fmac_f32 v129, v207, v128
    v_fmac_f32 v145, v207, v144
    v_fmac_f32 v129, v209, v144
    v_fmac_f32 v145, v208, v128
    v_mfma_f32_32x32x16_bf16 v[160:175], a[228:231], v[52:55], v[160:175]
    s_add_u32 s28, s21, 61440
    buffer_load_dwordx4 a[72:75], v2, s[56:59], s28 offen offset:0 sc1
    ds_read_b64_tr_b16 a[252:253], v204 offset:14336
    ds_read_b64_tr_b16 a[254:255], v204 offset:14848
    v_fmac_f32 v133, v207, v132
    v_fmac_f32 v149, v207, v148
    v_fmac_f32 v133, v209, v148
    v_fmac_f32 v149, v208, v132
    v_fmac_f32 v137, v207, v136
    s_waitcnt lgkmcnt(8)
    v_mfma_f32_32x32x16_bf16 v[160:175], a[232:235], v[56:59], v[160:175]
    ds_read_b64_tr_b16 a[224:225], v203 offset:8192
    ds_read_b64_tr_b16 a[226:227], v203 offset:8704
    v_fmac_f32 v153, v207, v152
    v_fmac_f32 v137, v209, v152
    buffer_load_dwordx4 a[76:79], v2, s[56:59], s28 offen offset:1024 sc1
    v_fmac_f32 v153, v208, v136
    v_fmac_f32 v141, v207, v140
    v_fmac_f32 v157, v207, v156
    v_mfma_f32_32x32x16_bf16 v[160:175], a[236:239], v[60:63], v[160:175]
    ds_read_b64_tr_b16 a[228:229], v203 offset:32768
    ds_read_b64_tr_b16 a[230:231], v203 offset:33280
    v_fmac_f32 v141, v209, v156
    v_fmac_f32 v157, v208, v140
    v_fmac_f32 v130, v207, v129
    v_fmac_f32 v146, v207, v145
    v_fmac_f32 v130, v209, v145
    s_waitcnt lgkmcnt(8)
    v_mfma_f32_32x32x16_bf16 v[160:175], a[240:243], v[64:67], v[160:175]
    ds_read_b64_tr_b16 a[232:233], v203 offset:57344
    ds_read_b64_tr_b16 a[234:235], v203 offset:57856
    buffer_load_dwordx4 a[80:83], v2, s[56:59], s28 offen offset:2048 sc1
    v_fmac_f32 v146, v208, v129
    v_fmac_f32 v134, v207, v133
    v_fmac_f32 v150, v207, v149
    v_fmac_f32 v134, v209, v149
    v_fmac_f32 v150, v208, v133
    v_fmac_f32 v138, v207, v137
    v_mfma_f32_32x32x16_bf16 v[160:175], a[244:247], v[68:71], v[160:175]
    ds_read_b64_tr_b16 a[236:237], v204 offset:16384
    ds_read_b64_tr_b16 a[238:239], v204 offset:16896
    v_fmac_f32 v154, v207, v153
    v_fmac_f32 v138, v209, v153
    v_fmac_f32 v154, v208, v137
    v_fmac_f32 v142, v207, v141
    v_fmac_f32 v158, v207, v157
    buffer_load_dwordx4 a[84:87], v2, s[56:59], s28 offen offset:3072 sc1
    s_waitcnt lgkmcnt(8)
    v_mfma_f32_32x32x16_bf16 v[160:175], a[248:251], v[72:75], v[160:175]
    ds_read_b64_tr_b16 a[240:241], v203 offset:10240
    ds_read_b64_tr_b16 a[242:243], v203 offset:10752
    v_fmac_f32 v142, v209, v157
    v_fmac_f32 v158, v208, v141
    v_fmac_f32 v131, v207, v130
    v_fmac_f32 v147, v207, v146
    v_fmac_f32 v131, v209, v146
    v_mfma_f32_32x32x16_bf16 v[160:175], a[252:255], v[76:79], v[160:175]
    ds_read_b64_tr_b16 a[244:245], v203 offset:34816
    ds_read_b64_tr_b16 a[246:247], v203 offset:35328
    v_fmac_f32 v147, v208, v130
    v_fmac_f32 v135, v207, v134
    v_fmac_f32 v151, v207, v150
    s_add_u32 s28, s21, 65536
    buffer_load_dwordx4 a[88:91], v2, s[56:59], s28 offen offset:0 sc1
    v_fmac_f32 v135, v209, v150
    v_fmac_f32 v151, v208, v134
    s_waitcnt lgkmcnt(8)
    v_mfma_f32_32x32x16_bf16 v[160:175], a[224:227], v[80:83], v[160:175]
    ds_read_b64_tr_b16 a[248:249], v203 offset:59392
    ds_read_b64_tr_b16 a[250:251], v203 offset:59904
    v_fmac_f32 v139, v207, v138
    v_fmac_f32 v155, v207, v154
    v_fmac_f32 v139, v209, v154
    v_fmac_f32 v155, v208, v138
    v_fmac_f32 v143, v207, v142
    v_mfma_f32_32x32x16_bf16 v[160:175], a[228:231], v[84:87], v[160:175]
    ds_read_b64_tr_b16 a[252:253], v204 offset:18432
    buffer_load_dwordx4 a[92:95], v2, s[56:59], s28 offen offset:1024 sc1
    ds_read_b64_tr_b16 a[254:255], v204 offset:18944
    v_fmac_f32 v159, v207, v158
    v_fmac_f32 v143, v209, v158
    v_fmac_f32 v159, v208, v142
    v_mov_b32 v232, v131
    v_mov_b32 v233, v131
    v_mov_b32 v234, v147
    s_waitcnt lgkmcnt(8)
    v_mfma_f32_32x32x16_bf16 v[160:175], a[232:235], v[88:91], v[160:175]
    ds_read_b64_tr_b16 a[224:225], v203 offset:12288
    ds_read_b64_tr_b16 a[226:227], v203 offset:12800
    v_mov_b32 v235, v147
    v_mov_b32 v236, v135
    v_mov_b32 v237, v135
    v_mov_b32 v238, v151
    v_mov_b32 v239, v151
    buffer_load_dwordx4 a[96:99], v2, s[56:59], s28 offen offset:2048 sc1
    v_mfma_f32_32x32x16_bf16 v[160:175], a[236:239], v[92:95], v[160:175]
    ds_read_b64_tr_b16 a[228:229], v203 offset:36864
    ds_read_b64_tr_b16 a[230:231], v203 offset:37376
    v_mov_b32 v240, v139
    v_mov_b32 v241, v139
    v_mov_b32 v242, v155
    v_mov_b32 v243, v155
    v_mov_b32 v244, v143
    s_waitcnt lgkmcnt(8)
    v_mfma_f32_32x32x16_bf16 v[160:175], a[240:243], v[96:99], v[160:175]
    ds_read_b64_tr_b16 a[232:233], v203 offset:61440
    ds_read_b64_tr_b16 a[234:235], v203 offset:61952
    v_mov_b32 v245, v143
    v_mov_b32 v246, v159
    buffer_load_dwordx4 a[100:103], v2, s[56:59], s28 offen offset:3072 sc1
    v_mov_b32 v247, v159
    v_permlane32_swap_b32 v232, v233
    v_permlane32_swap_b32 v234, v235
    v_mfma_f32_32x32x16_bf16 v[160:175], a[244:247], v[100:103], v[160:175]
    ds_read_b64_tr_b16 a[236:237], v204 offset:20480
    ds_read_b64_tr_b16 a[238:239], v204 offset:20992
    v_permlane32_swap_b32 v236, v237
    v_permlane32_swap_b32 v238, v239
    v_permlane32_swap_b32 v240, v241
    v_permlane32_swap_b32 v242, v243
    v_permlane32_swap_b32 v244, v245
    s_waitcnt lgkmcnt(8)
    v_mfma_f32_32x32x16_bf16 v[160:175], a[248:251], v[104:107], v[160:175]
    ds_read_b64_tr_b16 a[240:241], v205 offset:0
    ds_read_b64_tr_b16 a[242:243], v205 offset:512
    s_add_u32 s28, s21, 69632
    buffer_load_dwordx4 a[104:107], v2, s[56:59], s28 offen offset:0 sc1
    v_permlane32_swap_b32 v246, v247
    v_fma_f32 v194, v214, v232, v233
    v_fma_f32 v195, v214, v234, v235
    v_fma_f32 v194, -v215, v234, v194
    v_fmac_f32 v195, v215, v232
    v_fma_f32 v192, v214, v194, v236
    v_mfma_f32_32x32x16_bf16 v[160:175], a[252:255], v[108:111], v[160:175]
    ds_read_b64_tr_b16 a[244:245], v205 offset:24576
    ds_read_b64_tr_b16 a[246:247], v205 offset:25088
    v_fma_f32 v193, v214, v195, v238
    v_fma_f32 v192, -v215, v195, v192
    v_fmac_f32 v193, v215, v194
    buffer_load_dwordx4 a[108:111], v2, s[56:59], s28 offen offset:1024 sc1
    v_fma_f32 v194, v214, v192, v237
    v_fma_f32 v195, v214, v193, v239
    s_waitcnt lgkmcnt(8)
    v_mfma_f32_32x32x16_bf16 v[160:175], a[224:227], v[112:115], v[160:175]
    ds_read_b64_tr_b16 a[248:249], v205 offset:49152
    ds_read_b64_tr_b16 a[250:251], v205 offset:49664
    v_fma_f32 v194, -v215, v193, v194
    v_fmac_f32 v195, v215, v192
    v_fma_f32 v192, v214, v194, v240
    v_fma_f32 v193, v214, v195, v242
    v_fma_f32 v192, -v215, v195, v192
    v_mfma_f32_32x32x16_bf16 v[160:175], a[228:231], v[116:119], v[160:175]
    ds_read_b64_tr_b16 a[252:253], v206 offset:8192
    s_add_u32 s28, s21, 114688
    buffer_load_dwordx4 a[112:115], v2, s[56:59], s28 offen offset:0 sc1
    ds_read_b64_tr_b16 a[254:255], v206 offset:8704
    v_fmac_f32 v193, v215, v194
    v_fma_f32 v194, v214, v192, v241
    v_fma_f32 v195, v214, v193, v243
    v_fma_f32 v194, -v215, v193, v194
    v_fmac_f32 v195, v215, v192
    s_waitcnt lgkmcnt(8)
    v_mfma_f32_32x32x16_bf16 v[160:175], a[232:235], v[120:123], v[160:175]
    ds_read_b64_tr_b16 a[224:225], v205 offset:2048
    ds_read_b64_tr_b16 a[226:227], v205 offset:2560
    v_fma_f32 v192, v214, v194, v244
    v_fma_f32 v193, v214, v195, v246
    v_fma_f32 v192, -v215, v195, v192
    buffer_load_dwordx4 a[116:119], v2, s[56:59], s28 offen offset:1024 sc1
    v_fmac_f32 v193, v215, v194
    v_fma_f32 v194, v214, v192, v245
    v_mfma_f32_32x32x16_bf16 v[160:175], a[236:239], v[124:127], v[160:175]
    ds_read_b64_tr_b16 a[228:229], v205 offset:26624
    ds_read_b64_tr_b16 a[230:231], v205 offset:27136
    v_fma_f32 v195, v214, v193, v247
    v_fma_f32 v194, -v215, v193, v194
    v_fmac_f32 v195, v215, v192
    s_lshl_b32 s27, s10, 8
    v_lshl_add_u32 v3, v13, 3, s27
    ds_write_b64 v3, v[194:195] offset:1536
    s_waitcnt lgkmcnt(0)
    s_waitcnt vmcnt(13)
    s_barrier
    v_lshlrev_b32 v3, 3, v13
    ds_read_b64 v[224:225], v3 offset:1536
    ds_read_b64 v[226:227], v3 offset:1792
    ds_read_b64 v[228:229], v3 offset:2048
    ds_read_b64 v[230:231], v3 offset:2304
    v_mfma_f32_32x32x16_bf16 v[176:191], a[240:243], v[16:19], 0
    buffer_load_dwordx2 v[250:251], v252, s[56:59], 0 offen offset:3072 sc1
    ds_read_b64_tr_b16 a[232:233], v205 offset:51200
    ds_read_b64_tr_b16 a[234:235], v205 offset:51712
    s_waitcnt lgkmcnt(4)
    v_fma_f32 v3, v216, v224, v226
    v_fma_f32 v4, v216, v225, v227
    v_fma_f32 v3, -v217, v225, v3
    v_mfma_f32_32x32x16_bf16 v[176:191], a[244:247], v[20:23], v[176:191]
    buffer_load_dwordx4 a[120:123], v2, s[56:59], s28 offen offset:2048 sc1
    ds_read_b64_tr_b16 a[236:237], v206 offset:10240
    ds_read_b64_tr_b16 a[238:239], v206 offset:10752
    v_fmac_f32 v4, v217, v224
    s_waitcnt lgkmcnt(5)
    v_fma_f32 v5, v216, v3, v228
    v_fma_f32 v6, v216, v4, v229
    v_mfma_f32_32x32x16_bf16 v[176:191], a[248:251], v[24:27], v[176:191]
    ds_read_b64_tr_b16 a[240:241], v205 offset:4096
    ds_read_b64_tr_b16 a[242:243], v205 offset:4608
    v_fma_f32 v5, -v217, v4, v5
    v_fmac_f32 v6, v217, v3
    s_waitcnt lgkmcnt(6)
    v_fma_f32 v192, v216, v5, v230
    v_fma_f32 v193, v216, v6, v231
    buffer_load_dwordx4 a[124:127], v2, s[56:59], s28 offen offset:3072 sc1
    v_mfma_f32_32x32x16_bf16 v[176:191], a[252:255], v[28:31], v[176:191]
    ds_read_b64_tr_b16 a[244:245], v205 offset:28672
    ds_read_b64_tr_b16 a[246:247], v205 offset:29184
    v_fma_f32 v192, -v217, v6, v192
    v_fmac_f32 v193, v217, v5
    v_mov_b32 v194, s12
    v_mfma_f32_32x32x16_bf16 v[176:191], a[224:227], v[32:35], v[176:191]
    ds_read_b64_tr_b16 a[248:249], v205 offset:53248
    ds_read_b64_tr_b16 a[250:251], v205 offset:53760
    v_mov_b32 v195, s13
    s_lshl_b32 s27, s10, 3
    s_lshl_b32 s27, 0xff, s27
    s_add_u32 s28, s21, 118784
    buffer_load_dwordx4 a[128:131], v2, s[56:59], s28 offen offset:0 sc1
    s_lshl_b32 s98, s8, 9
    s_mov_b32 exec_lo, s27
    s_mov_b32 exec_hi, 0
    buffer_store_dwordx4 v[192:195], v2, s[44:47], s98 offen sc1
    s_mov_b64 exec, -1
    v_mfma_f32_32x32x16_bf16 v[176:191], a[228:231], v[36:39], v[176:191]
    ds_read_b64_tr_b16 a[252:253], v206 offset:12288
    ds_read_b64_tr_b16 a[254:255], v206 offset:12800
    v_mul_f32 v3, v9, v160
    v_mul_f32 v4, v9, v161
    v_mul_f32 v5, v9, v162
    v_mul_f32 v196, v9, v163
    s_waitcnt lgkmcnt(8)
    v_mfma_f32_32x32x16_bf16 v[176:191], a[232:235], v[40:43], v[176:191]
    buffer_load_dwordx4 a[132:135], v2, s[56:59], s28 offen offset:1024 sc1
    ds_read_b64_tr_b16 a[224:225], v205 offset:6144
    ds_read_b64_tr_b16 a[226:227], v205 offset:6656
    v_exp_f32 v3, v3
    v_exp_f32 v4, v4
    v_exp_f32 v5, v5
    v_exp_f32 v196, v196
    v_fma_f32 v3, v3, v8, v8
    v_mfma_f32_32x32x16_bf16 v[176:191], a[236:239], v[44:47], v[176:191]
    ds_read_b64_tr_b16 a[228:229], v205 offset:30720
    buffer_load_dwordx4 a[136:139], v2, s[56:59], s28 offen offset:2048 sc1
    ds_read_b64_tr_b16 a[230:231], v205 offset:31232
    v_fma_f32 v4, v4, v8, v8
    v_fma_f32 v5, v5, v8, v8
    v_fma_f32 v196, v196, v8, v8
    v_rcp_f32 v3, v3
    s_waitcnt lgkmcnt(8)
    v_mfma_f32_32x32x16_bf16 v[176:191], a[240:243], v[48:51], v[176:191]
    ds_read_b64_tr_b16 a[232:233], v205 offset:55296
    ds_read_b64_tr_b16 a[234:235], v205 offset:55808
    v_rcp_f32 v4, v4
    v_rcp_f32 v5, v5
    v_rcp_f32 v196, v196
    buffer_load_dwordx4 a[140:143], v2, s[56:59], s28 offen offset:3072 sc1
    v_mul_f32 v160, v160, v3
    v_mul_f32 v161, v161, v4
    v_mfma_f32_32x32x16_bf16 v[176:191], a[244:247], v[52:55], v[176:191]
    ds_read_b64_tr_b16 a[236:237], v206 offset:14336
    ds_read_b64_tr_b16 a[238:239], v206 offset:14848
    v_mul_f32 v162, v162, v5
    v_mul_f32 v163, v163, v196
    v_cvt_pk_bf16_f32 v160, v160, v161
    v_cvt_pk_bf16_f32 v161, v162, v163
    s_waitcnt lgkmcnt(8)
    v_mfma_f32_32x32x16_bf16 v[176:191], a[248:251], v[56:59], v[176:191]
    ds_read_b64_tr_b16 a[240:241], v205 offset:8192
    ds_read_b64_tr_b16 a[242:243], v205 offset:8704
    s_add_u32 s28, s21, 122880
    buffer_load_dwordx4 a[144:147], v2, s[56:59], s28 offen offset:0 sc1
    v_mul_f32 v3, v9, v164
    v_mul_f32 v4, v9, v165
    v_mul_f32 v5, v9, v166
    v_mul_f32 v196, v9, v167
    v_exp_f32 v3, v3
    v_mfma_f32_32x32x16_bf16 v[176:191], a[252:255], v[60:63], v[176:191]
    ds_read_b64_tr_b16 a[244:245], v205 offset:32768
    ds_read_b64_tr_b16 a[246:247], v205 offset:33280
    v_exp_f32 v4, v4
    v_exp_f32 v5, v5
    buffer_load_dwordx4 a[148:151], v2, s[56:59], s28 offen offset:1024 sc1
    v_exp_f32 v196, v196
    v_fma_f32 v3, v3, v8, v8
    s_waitcnt lgkmcnt(8)
    v_mfma_f32_32x32x16_bf16 v[176:191], a[224:227], v[64:67], v[176:191]
    ds_read_b64_tr_b16 a[248:249], v205 offset:57344
    ds_read_b64_tr_b16 a[250:251], v205 offset:57856
    v_fma_f32 v4, v4, v8, v8
    v_fma_f32 v5, v5, v8, v8
    v_fma_f32 v196, v196, v8, v8
    v_rcp_f32 v3, v3
    v_rcp_f32 v4, v4
    v_mfma_f32_32x32x16_bf16 v[176:191], a[228:231], v[68:71], v[176:191]
    buffer_load_dwordx4 a[152:155], v2, s[56:59], s28 offen offset:2048 sc1
    ds_read_b64_tr_b16 a[252:253], v206 offset:16384
    ds_read_b64_tr_b16 a[254:255], v206 offset:16896
    v_rcp_f32 v5, v5
    v_rcp_f32 v196, v196
    v_mul_f32 v164, v164, v3
    v_mul_f32 v165, v165, v4
    s_waitcnt lgkmcnt(8)
    v_mfma_f32_32x32x16_bf16 v[176:191], a[232:235], v[72:75], v[176:191]
    ds_read_b64_tr_b16 a[224:225], v205 offset:10240
    ds_read_b64_tr_b16 a[226:227], v205 offset:10752
    v_mul_f32 v166, v166, v5
    v_mul_f32 v167, v167, v196
    buffer_load_dwordx4 a[156:159], v2, s[56:59], s28 offen offset:3072 sc1
    v_cvt_pk_bf16_f32 v162, v164, v165
    v_cvt_pk_bf16_f32 v163, v166, v167
    s_add_u32 s101, s16, 0
    v_mfma_f32_32x32x16_bf16 v[176:191], a[236:239], v[76:79], v[176:191]
    ds_read_b64_tr_b16 a[228:229], v205 offset:34816
    ds_read_b64_tr_b16 a[230:231], v205 offset:35328
    buffer_store_dwordx4 v[160:163], v2, s[56:59], s101 offen sc1
    v_mul_f32 v3, v9, v168
    v_mul_f32 v4, v9, v169
    v_mul_f32 v5, v9, v170
    v_mul_f32 v196, v9, v171
    s_waitcnt lgkmcnt(8)
    v_mfma_f32_32x32x16_bf16 v[176:191], a[240:243], v[80:83], v[176:191]
    s_add_u32 s28, s21, 126976
    buffer_load_dwordx4 a[160:163], v2, s[56:59], s28 offen offset:0 sc1
    ds_read_b64_tr_b16 a[232:233], v205 offset:59392
    ds_read_b64_tr_b16 a[234:235], v205 offset:59904
    v_exp_f32 v3, v3
    v_exp_f32 v4, v4
    v_exp_f32 v5, v5
    v_exp_f32 v196, v196
    v_mfma_f32_32x32x16_bf16 v[176:191], a[244:247], v[84:87], v[176:191]
    ds_read_b64_tr_b16 a[236:237], v206 offset:18432
    ds_read_b64_tr_b16 a[238:239], v206 offset:18944
    v_fma_f32 v3, v3, v8, v8
    buffer_load_dwordx4 a[164:167], v2, s[56:59], s28 offen offset:1024 sc1
    v_fma_f32 v4, v4, v8, v8
    v_fma_f32 v5, v5, v8, v8
    v_fma_f32 v196, v196, v8, v8
    v_rcp_f32 v3, v3
    s_waitcnt lgkmcnt(8)
    v_mfma_f32_32x32x16_bf16 v[176:191], a[248:251], v[88:91], v[176:191]
    ds_read_b64_tr_b16 a[240:241], v205 offset:12288
    ds_read_b64_tr_b16 a[242:243], v205 offset:12800
    v_rcp_f32 v4, v4
    v_rcp_f32 v5, v5
    v_rcp_f32 v196, v196
    s_waitcnt vmcnt(14)
    v_cmp_ne_u32 vcc, s12, v250
    v_cmp_ne_u32 s[30:31], s13, v251
    s_nop 1
    s_or_b32 s37, vcc_lo, s30
    s_and_b32 s37, s37, s69
    s_cbranch_scc1 L_retry_p3
L_ok_p3:
    v_mul_f32 v168, v168, v3
    v_mfma_f32_32x32x16_bf16 v[176:191], a[252:255], v[92:95], v[176:191]
    s_add_u32 s28, s21, 172032
    buffer_load_dwordx4 a[168:171], v2, s[56:59], s28 offen offset:0 sc1
    ds_read_b64_tr_b16 a[244:245], v205 offset:36864
    ds_read_b64_tr_b16 a[246:247], v205 offset:37376
    v_mul_f32 v169, v169, v4
    v_mul_f32 v170, v170, v5
    v_mul_f32 v171, v171, v196
    v_cvt_pk_bf16_f32 v164, v168, v169
    v_cvt_pk_bf16_f32 v165, v170, v171
    s_waitcnt lgkmcnt(8)
    v_mfma_f32_32x32x16_bf16 v[176:191], a[224:227], v[96:99], v[176:191]
    ds_read_b64_tr_b16 a[248:249], v205 offset:61440
    ds_read_b64_tr_b16 a[250:251], v205 offset:61952
    v_mul_f32 v3, v9, v172
    v_mul_f32 v4, v9, v173
    buffer_load_dwordx4 a[172:175], v2, s[56:59], s28 offen offset:1024 sc1
    v_mul_f32 v5, v9, v174
    v_mul_f32 v196, v9, v175
    v_mfma_f32_32x32x16_bf16 v[176:191], a[228:231], v[100:103], v[176:191]
    ds_read_b64_tr_b16 a[252:253], v206 offset:20480
    ds_read_b64_tr_b16 a[254:255], v206 offset:20992
    v_exp_f32 v3, v3
    v_exp_f32 v4, v4
    v_exp_f32 v5, v5
    v_exp_f32 v196, v196
    v_fma_f32 v3, v3, v8, v8
    s_waitcnt lgkmcnt(8)
    v_mfma_f32_32x32x16_bf16 v[176:191], a[232:235], v[104:107], v[176:191]
    buffer_load_dwordx4 a[176:179], v2, s[56:59], s28 offen offset:2048 sc1
    ds_read_b64_tr_b16 a[224:225], v203 offset:14336
    ds_read_b64_tr_b16 a[226:227], v203 offset:14848
    v_fma_f32 v4, v4, v8, v8
    v_fma_f32 v5, v5, v8, v8
    v_fma_f32 v196, v196, v8, v8
    v_rcp_f32 v3, v3
    v_mfma_f32_32x32x16_bf16 v[176:191], a[236:239], v[108:111], v[176:191]
    ds_read_b64_tr_b16 a[228:229], v203 offset:38912
    ds_read_b64_tr_b16 a[230:231], v203 offset:39424
    v_rcp_f32 v4, v4
    buffer_load_dwordx4 a[180:183], v2, s[56:59], s28 offen offset:3072 sc1
    v_rcp_f32 v5, v5
    v_rcp_f32 v196, v196
    v_mul_f32 v172, v172, v3
    v_mul_f32 v173, v173, v4
    s_waitcnt lgkmcnt(8)
    v_mfma_f32_32x32x16_bf16 v[176:191], a[240:243], v[112:115], v[176:191]
    ds_read_b64_tr_b16 a[232:233], v203 offset:63488
    ds_read_b64_tr_b16 a[234:235], v203 offset:64000
    v_mul_f32 v174, v174, v5
    v_mul_f32 v175, v175, v196
    v_cvt_pk_bf16_f32 v166, v172, v173
    v_cvt_pk_bf16_f32 v167, v174, v175
    buffer_store_dwordx4 v[164:167], v2, s[56:59], s101 offen offset:1024 sc1
    buffer_load_dwordx2 v[250:251], v252, s[56:59], s68 offen sc1
    v_mfma_f32_32x32x16_bf16 v[176:191], a[244:247], v[116:119], v[176:191]
    ds_read_b64_tr_b16 a[236:237], v204 offset:22528
    ds_read_b64_tr_b16 a[238:239], v204 offset:23040
    s_waitcnt lgkmcnt(8)
    v_mfma_f32_32x32x16_bf16 v[176:191], a[248:251], v[120:123], v[176:191]
    s_add_u32 s28, s21, 176128
    buffer_load_dwordx4 a[184:187], v2, s[56:59], s28 offen offset:0 sc1
    ds_read_b64_tr_b16 a[240:241], v203 offset:16384
    ds_read_b64_tr_b16 a[242:243], v203 offset:16896
    v_mfma_f32_32x32x16_bf16 v[176:191], a[252:255], v[124:127], v[176:191]
    ds_read_b64_tr_b16 a[244:245], v203 offset:40960
    ds_read_b64_tr_b16 a[246:247], v203 offset:41472
    s_waitcnt lgkmcnt(8)
    v_mfma_f32_32x32x16_bf16 v[160:175], a[224:227], v[16:19], 0
    ds_read_b64_tr_b16 a[248:249], v204 offset:0
    ds_read_b64_tr_b16 a[250:251], v204 offset:512
    v_mfma_f32_32x32x16_bf16 v[160:175], a[228:231], v[20:23], v[160:175]
    ds_read_b64_tr_b16 a[252:253], v204 offset:24576
    ds_read_b64_tr_b16 a[254:255], v204 offset:25088
    s_waitcnt lgkmcnt(8)
    v_mfma_f32_32x32x16_bf16 v[160:175], a[232:235], v[24:27], v[160:175]
    buffer_load_dwordx4 a[188:191], v2, s[56:59], s28 offen offset:1024 sc1
    ds_read_b64_tr_b16 a[224:225], v203 offset:18432
    ds_read_b64_tr_b16 a[226:227], v203 offset:18944
    v_mfma_f32_32x32x16_bf16 v[160:175], a[236:239], v[28:31], v[160:175]
    ds_read_b64_tr_b16 a[228:229], v203 offset:43008
    ds_read_b64_tr_b16 a[230:231], v203 offset:43520
    v_mul_f32 v3, v9, v176
    v_mul_f32 v4, v9, v177
    v_mul_f32 v5, v9, v178
    v_mul_f32 v196, v9, v179
    s_waitcnt lgkmcnt(8)
    v_mfma_f32_32x32x16_bf16 v[160:175], a[240:243], v[32:35], v[160:175]
    buffer_load_dwordx4 a[192:195], v2, s[56:59], s28 offen offset:2048 sc1
    ds_read_b64_tr_b16 a[232:233], v204 offset:2048
    ds_read_b64_tr_b16 a[234:235], v204 offset:2560
    v_exp_f32 v3, v3
    v_exp_f32 v4, v4
    v_exp_f32 v5, v5
    v_exp_f32 v196, v196
    v_mfma_f32_32x32x16_bf16 v[160:175], a[244:247], v[36:39], v[160:175]
    ds_read_b64_tr_b16 a[236:237], v204 offset:26624
    ds_read_b64_tr_b16 a[238:239], v204 offset:27136
    buffer_load_dwordx4 a[196:199], v2, s[56:59], s28 offen offset:3072 sc1
    v_fma_f32 v3, v3, v8, v8
    v_fma_f32 v4, v4, v8, v8
    v_fma_f32 v5, v5, v8, v8
    v_fma_f32 v196, v196, v8, v8
    v_rcp_f32 v3, v3
    s_waitcnt lgkmcnt(8)
    v_mfma_f32_32x32x16_bf16 v[160:175], a[248:251], v[40:43], v[160:175]
    ds_read_b64_tr_b16 a[240:241], v203 offset:20480
    ds_read_b64_tr_b16 a[242:243], v203 offset:20992
    v_rcp_f32 v4, v4
    v_rcp_f32 v5, v5
    v_rcp_f32 v196, v196
    s_add_u32 s28, s21, 180224
    buffer_load_dwordx4 a[200:203], v2, s[56:59], s28 offen offset:0 sc1
    v_mul_f32 v176, v176, v3
    v_mfma_f32_32x32x16_bf16 v[160:175], a[252:255], v[44:47], v[160:175]
    ds_read_b64_tr_b16 a[244:245], v203 offset:45056
    ds_read_b64_tr_b16 a[246:247], v203 offset:45568
    v_mul_f32 v177, v177, v4
    v_mul_f32 v178, v178, v5
    v_mul_f32 v179, v179, v196
    v_cvt_pk_bf16_f32 v176, v176, v177
    s_waitcnt lgkmcnt(8)
    v_mfma_f32_32x32x16_bf16 v[160:175], a[224:227], v[48:51], v[160:175]
    ds_read_b64_tr_b16 a[248:249], v204 offset:4096
    ds_read_b64_tr_b16 a[250:251], v204 offset:4608
    buffer_load_dwordx4 a[204:207], v2, s[56:59], s28 offen offset:1024 sc1
    v_cvt_pk_bf16_f32 v177, v178, v179
    v_mul_f32 v3, v9, v180
    v_mul_f32 v4, v9, v181
    v_mul_f32 v5, v9, v182
    v_mul_f32 v196, v9, v183
    v_mfma_f32_32x32x16_bf16 v[160:175], a[228:231], v[52:55], v[160:175]
    ds_read_b64_tr_b16 a[252:253], v204 offset:28672
    ds_read_b64_tr_b16 a[254:255], v204 offset:29184
    v_exp_f32 v3, v3
    v_exp_f32 v4, v4
    v_exp_f32 v5, v5
    buffer_load_dwordx4 a[208:211], v2, s[56:59], s28 offen offset:2048 sc1
    v_exp_f32 v196, v196
    s_waitcnt lgkmcnt(8)
    v_mfma_f32_32x32x16_bf16 v[160:175], a[232:235], v[56:59], v[160:175]
    ds_read_b64_tr_b16 a[224:225], v203 offset:22528
    ds_read_b64_tr_b16 a[226:227], v203 offset:23040
    v_fma_f32 v3, v3, v8, v8
    v_fma_f32 v4, v4, v8, v8
    v_fma_f32 v5, v5, v8, v8
    v_fma_f32 v196, v196, v8, v8
    v_mfma_f32_32x32x16_bf16 v[160:175], a[236:239], v[60:63], v[160:175]
    ds_read_b64_tr_b16 a[228:229], v203 offset:47104
    ds_read_b64_tr_b16 a[230:231], v203 offset:47616
    v_rcp_f32 v3, v3
    buffer_load_dwordx4 a[212:215], v2, s[56:59], s28 offen offset:3072 sc1
    v_rcp_f32 v4, v4
    v_rcp_f32 v5, v5
    v_rcp_f32 v196, v196
    v_mul_f32 v180, v180, v3
    s_waitcnt lgkmcnt(8)
    v_mfma_f32_32x32x16_bf16 v[160:175], a[240:243], v[64:67], v[160:175]
    ds_read_b64_tr_b16 a[232:233], v204 offset:6144
    ds_read_b64_tr_b16 a[234:235], v204 offset:6656
    v_mul_f32 v181, v181, v4
    v_mul_f32 v182, v182, v5
    v_mul_f32 v183, v183, v196
    s_add_u32 s28, s21, 184320
    buffer_load_dwordx4 a[216:219], v2, s[56:59], s28 offen offset:0 sc1
    v_cvt_pk_bf16_f32 v178, v180, v181
    v_mfma_f32_32x32x16_bf16 v[160:175], a[244:247], v[68:71], v[160:175]
    ds_read_b64_tr_b16 a[236:237], v204 offset:30720
    ds_read_b64_tr_b16 a[238:239], v204 offset:31232
    v_cvt_pk_bf16_f32 v179, v182, v183
    s_add_u32 s101, s16, 28672
    buffer_store_dwordx4 v[176:179], v2, s[56:59], s101 offen sc1
    v_mul_f32 v3, v9, v184
    s_waitcnt lgkmcnt(8)
    v_mfma_f32_32x32x16_bf16 v[160:175], a[248:251], v[72:75], v[160:175]
    ds_read_b64_tr_b16 a[240:241], v204 offset:32768
    ds_read_b64_tr_b16 a[242:243], v204 offset:33280
    buffer_load_dwordx4 a[220:223], v2, s[56:59], s28 offen offset:1024 sc1
    v_mul_f32 v4, v9, v185
    v_mul_f32 v5, v9, v186
    v_mul_f32 v196, v9, v187
    v_exp_f32 v3, v3
    v_exp_f32 v4, v4
    v_mfma_f32_32x32x16_bf16 v[160:175], a[252:255], v[76:79], v[160:175]
    ds_read_b64_tr_b16 a[244:245], v204 offset:36864
    ds_read_b64_tr_b16 a[246:247], v204 offset:37376
    v_exp_f32 v5, v5
    v_exp_f32 v196, v196
    v_fma_f32 v3, v3, v8, v8
    s_waitcnt vmcnt(11)
    v_cmp_ne_u32 vcc, s12, v250
    v_cmp_ne_u32 s[30:31], s13, v251
    s_nop 1
    s_or_b32 s37, vcc_lo, s30
    s_and_b32 s37, s37, 0x7f7f
    s_cbranch_scc1 L_retry_p4
L_ok_p4:
    v_fma_f32 v4, v4, v8, v8
    s_waitcnt lgkmcnt(8)
    v_mfma_f32_32x32x16_bf16 v[160:175], a[224:227], v[80:83], v[160:175]
    ds_read_b64_tr_b16 a[248:249], v204 offset:40960
    ds_read_b64_tr_b16 a[250:251], v204 offset:41472
    v_fma_f32 v5, v5, v8, v8
    v_fma_f32 v196, v196, v8, v8
    v_rcp_f32 v3, v3
    v_rcp_f32 v4, v4
    v_mfma_f32_32x32x16_bf16 v[160:175], a[228:231], v[84:87], v[160:175]
    ds_read_b64_tr_b16 a[252:253], v204 offset:45056
    ds_read_b64_tr_b16 a[254:255], v204 offset:45568
    v_rcp_f32 v5, v5
    v_rcp_f32 v196, v196
    v_mul_f32 v184, v184, v3
    v_mul_f32 v185, v185, v4
    v_mul_f32 v186, v186, v5
    s_waitcnt lgkmcnt(8)
    v_mfma_f32_32x32x16_bf16 v[160:175], a[232:235], v[88:91], v[160:175]
    ds_read_b64_tr_b16 a[224:225], v204 offset:34816
    ds_read_b64_tr_b16 a[226:227], v204 offset:35328
    v_mul_f32 v187, v187, v196
    v_cvt_pk_bf16_f32 v180, v184, v185
    v_cvt_pk_bf16_f32 v181, v186, v187
    v_mul_f32 v3, v9, v188
    v_mfma_f32_32x32x16_bf16 v[160:175], a[236:239], v[92:95], v[160:175]
    ds_read_b64_tr_b16 a[228:229], v204 offset:38912
    ds_read_b64_tr_b16 a[230:231], v204 offset:39424
    v_mul_f32 v4, v9, v189
    v_mul_f32 v5, v9, v190
    v_mul_f32 v196, v9, v191
    v_exp_f32 v3, v3
    s_waitcnt lgkmcnt(8)
    v_mfma_f32_32x32x16_bf16 v[160:175], a[240:243], v[96:99], v[160:175]
    ds_read_b64_tr_b16 a[232:233], v204 offset:43008
    ds_read_b64_tr_b16 a[234:235], v204 offset:43520
    v_exp_f32 v4, v4
    s_add_u32 s37, s25, 0
    s_mov_b64 exec, 1
    buffer_store_dwordx2 v[254:255], v11, s[56:59], s37 offen sc1
    s_mov_b64 exec, -1
    v_exp_f32 v5, v5
    v_exp_f32 v196, v196
    v_fma_f32 v3, v3, v8, v8
    v_fma_f32 v4, v4, v8, v8
    v_mfma_f32_32x32x16_bf16 v[160:175], a[244:247], v[100:103], v[160:175]
    ds_read_b64_tr_b16 a[236:237], v204 offset:47104
    ds_read_b64_tr_b16 a[238:239], v204 offset:47616
    v_fma_f32 v5, v5, v8, v8
    v_fma_f32 v196, v196, v8, v8
    v_rcp_f32 v3, v3
    v_rcp_f32 v4, v4
    s_waitcnt lgkmcnt(8)
    v_mfma_f32_32x32x16_bf16 v[160:175], a[248:251], v[104:107], v[160:175]
    ds_read_b64_tr_b16 a[240:241], v205 offset:14336
    ds_read_b64_tr_b16 a[242:243], v205 offset:14848
    v_rcp_f32 v5, v5
    v_rcp_f32 v196, v196
    v_mul_f32 v188, v188, v3
    v_mul_f32 v189, v189, v4
    v_mfma_f32_32x32x16_bf16 v[160:175], a[252:255], v[108:111], v[160:175]
    ds_read_b64_tr_b16 a[244:245], v205 offset:38912
    ds_read_b64_tr_b16 a[246:247], v205 offset:39424
    v_mul_f32 v190, v190, v5
    v_mul_f32 v191, v191, v196
    v_cvt_pk_bf16_f32 v182, v188, v189
    v_cvt_pk_bf16_f32 v183, v190, v191
    buffer_store_dwordx4 v[180:183], v2, s[56:59], s101 offen offset:1024 sc1
    s_waitcnt lgkmcnt(8)
    v_mfma_f32_32x32x16_bf16 v[160:175], a[224:227], v[112:115], v[160:175]
    ds_read_b64_tr_b16 a[248:249], v205 offset:63488
    ds_read_b64_tr_b16 a[250:251], v205 offset:64000
    v_mfma_f32_32x32x16_bf16 v[160:175], a[228:231], v[116:119], v[160:175]
    ds_read_b64_tr_b16 a[252:253], v206 offset:22528
    ds_read_b64_tr_b16 a[254:255], v206 offset:23040
    s_waitcnt lgkmcnt(8)
    v_mfma_f32_32x32x16_bf16 v[160:175], a[232:235], v[120:123], v[160:175]
    ds_read_b64_tr_b16 a[224:225], v205 offset:16384
    ds_read_b64_tr_b16 a[226:227], v205 offset:16896
    v_mfma_f32_32x32x16_bf16 v[160:175], a[236:239], v[124:127], v[160:175]
    ds_read_b64_tr_b16 a[228:229], v205 offset:40960
    ds_read_b64_tr_b16 a[230:231], v205 offset:41472
    s_waitcnt lgkmcnt(8)
    v_mfma_f32_32x32x16_bf16 v[176:191], a[240:243], v[16:19], 0
    ds_read_b64_tr_b16 a[232:233], v206 offset:0
    ds_read_b64_tr_b16 a[234:235], v206 offset:512
    v_mfma_f32_32x32x16_bf16 v[176:191], a[244:247], v[20:23], v[176:191]
    ds_read_b64_tr_b16 a[236:237], v206 offset:24576
    ds_read_b64_tr_b16 a[238:239], v206 offset:25088
    s_waitcnt lgkmcnt(8)
    v_mfma_f32_32x32x16_bf16 v[176:191], a[248:251], v[24:27], v[176:191]
    ds_read_b64_tr_b16 a[240:241], v205 offset:18432
    ds_read_b64_tr_b16 a[242:243], v205 offset:18944
    v_mfma_f32_32x32x16_bf16 v[176:191], a[252:255], v[28:31], v[176:191]
    ds_read_b64_tr_b16 a[244:245], v205 offset:43008
    ds_read_b64_tr_b16 a[246:247], v205 offset:43520
    v_mul_f32 v3, v9, v160
    v_mul_f32 v4, v9, v161
    v_mul_f32 v5, v9, v162
    v_mul_f32 v196, v9, v163
    s_waitcnt lgkmcnt(8)
    v_mfma_f32_32x32x16_bf16 v[176:191], a[224:227], v[32:35], v[176:191]
    ds_read_b64_tr_b16 a[248:249], v206 offset:2048
    ds_read_b64_tr_b16 a[250:251], v206 offset:2560
    v_exp_f32 v3, v3
    v_exp_f32 v4, v4
    v_exp_f32 v5, v5
    v_exp_f32 v196, v196
    v_mfma_f32_32x32x16_bf16 v[176:191], a[228:231], v[36:39], v[176:191]
    ds_read_b64_tr_b16 a[252:253], v206 offset:26624
    ds_read_b64_tr_b16 a[254:255], v206 offset:27136
    v_fma_f32 v3, v3, v8, v8
    v_fma_f32 v4, v4, v8, v8
    v_fma_f32 v5, v5, v8, v8
    v_fma_f32 v196, v196, v8, v8
    v_rcp_f32 v3, v3
    s_waitcnt lgkmcnt(8)
    v_mfma_f32_32x32x16_bf16 v[176:191], a[232:235], v[40:43], v[176:191]
    ds_read_b64_tr_b16 a[224:225], v205 offset:20480
    ds_read_b64_tr_b16 a[226:227], v205 offset:20992
    v_rcp_f32 v4, v4
    v_rcp_f32 v5, v5
    v_rcp_f32 v196, v196
    v_mul_f32 v160, v160, v3
    v_mfma_f32_32x32x16_bf16 v[176:191], a[236:239], v[44:47], v[176:191]
    ds_read_b64_tr_b16 a[228:229], v205 offset:45056
    ds_read_b64_tr_b16 a[230:231], v205 offset:45568
    v_mul_f32 v161, v161, v4
    v_mul_f32 v162, v162, v5
    v_mul_f32 v163, v163, v196
    v_cvt_pk_bf16_f32 v160, v160, v161
    s_waitcnt lgkmcnt(8)
    v_mfma_f32_32x32x16_bf16 v[176:191], a[240:243], v[48:51], v[176:191]
    s_add_u32 s28, s32, 229376
    buffer_load_dwordx4 v[48:51], v2, s[56:59], s28 offen offset:0 sc1
    ds_read_b64_tr_b16 a[232:233], v206 offset:4096
    ds_read_b64_tr_b16 a[234:235], v206 offset:4608
    v_cvt_pk_bf16_f32 v161, v162, v163
    v_mul_f32 v3, v9, v164
    v_mul_f32 v4, v9, v165
    v_mul_f32 v5, v9, v166
    v_mul_f32 v196, v9, v167
    v_mfma_f32_32x32x16_bf16 v[176:191], a[244:247], v[52:55], v[176:191]
    buffer_load_dwordx4 v[52:55], v2, s[56:59], s28 offen offset:1024 sc1
    ds_read_b64_tr_b16 a[236:237], v206 offset:28672
    ds_read_b64_tr_b16 a[238:239], v206 offset:29184
    v_exp_f32 v3, v3
    v_exp_f32 v4, v4
    v_exp_f32 v5, v5
    v_exp_f32 v196, v196
    s_waitcnt lgkmcnt(8)
    v_mfma_f32_32x32x16_bf16 v[176:191], a[248:251], v[56:59], v[176:191]
    buffer_load_dwordx4 v[56:59], v2, s[56:59], s28 offen offset:2048 sc1
    ds_read_b64_tr_b16 a[240:241], v205 offset:22528
    s_sub_u32 s98, s8, 1
    s_lshl_b32 s98, s98, 9
    v_lshlrev_b32 v200, 9, v12
    v_sub_u32 v200, s98, v200
    v_lshl_add_u32 v199, v13, 4, v200
    buffer_load_dwordx4 v[16:19], v199, s[44:47], 0 offen sc1
    v_subrev_u32 v200, 1024, v199
    buffer_load_dwordx4 v[20:23], v200, s[44:47], 0 offen sc1
    v_subrev_u32 v200, 2048, v199
    buffer_load_dwordx4 v[24:27], v200, s[44:47], 0 offen sc1
    v_subrev_u32 v200, 3072, v199
    buffer_load_dwordx4 v[28:31], v200, s[44:47], 0 offen sc1
    ds_read_b64_tr_b16 a[242:243], v205 offset:23040
    v_fma_f32 v3, v3, v8, v8
    v_fma_f32 v4, v4, v8, v8
    v_fma_f32 v5, v5, v8, v8
    v_fma_f32 v196, v196, v8, v8
    v_mfma_f32_32x32x16_bf16 v[176:191], a[252:255], v[60:63], v[176:191]
    buffer_load_dwordx4 v[60:63], v2, s[56:59], s28 offen offset:3072 sc1
    ds_read_b64_tr_b16 a[244:245], v205 offset:47104
    v_subrev_u32 v200, 4096, v199
    buffer_load_dwordx4 v[32:35], v200, s[44:47], 0 offen sc1
    v_subrev_u32 v200, 5120, v199
    buffer_load_dwordx4 v[36:39], v200, s[44:47], 0 offen sc1
    v_subrev_u32 v200, 6144, v199
    buffer_load_dwordx4 v[40:43], v200, s[44:47], 0 offen sc1
    v_subrev_u32 v200, 7168, v199
    buffer_load_dwordx4 v[44:47], v200, s[44:47], 0 offen sc1
    ds_read_b64_tr_b16 a[246:247], v205 offset:47616
    v_rcp_f32 v3, v3
    v_rcp_f32 v4, v4
    v_rcp_f32 v5, v5
    v_rcp_f32 v196, v196
    v_mul_f32 v164, v164, v3
    s_waitcnt lgkmcnt(8)
    v_mfma_f32_32x32x16_bf16 v[176:191], a[224:227], v[64:67], v[176:191]
    s_add_u32 s28, s32, 233472
    buffer_load_dwordx4 v[64:67], v2, s[56:59], s28 offen offset:0 sc1
    ds_read_b64_tr_b16 a[248:249], v206 offset:6144
    ds_read_b64_tr_b16 a[250:251], v206 offset:6656
    v_mul_f32 v165, v165, v4
    v_mul_f32 v166, v166, v5
    v_mul_f32 v167, v167, v196
    v_cvt_pk_bf16_f32 v162, v164, v165
    v_mfma_f32_32x32x16_bf16 v[176:191], a[228:231], v[68:71], v[176:191]
    buffer_load_dwordx4 v[68:71], v2, s[56:59], s28 offen offset:1024 sc1
    ds_read_b64_tr_b16 a[252:253], v206 offset:30720
    ds_read_b64_tr_b16 a[254:255], v206 offset:31232
    v_cvt_pk_bf16_f32 v163, v166, v167
    s_add_u32 s101, s16, 57344
    buffer_store_dwordx4 v[160:163], v2, s[56:59], s101 offen sc1
    v_mul_f32 v3, v9, v168
    s_waitcnt lgkmcnt(8)
    v_mfma_f32_32x32x16_bf16 v[176:191], a[232:235], v[72:75], v[176:191]
    buffer_load_dwordx4 v[72:75], v2, s[56:59], s28 offen offset:2048 sc1
    ds_read_b64_tr_b16 a[224:225], v206 offset:32768
    ds_read_b64_tr_b16 a[226:227], v206 offset:33280
    v_mul_f32 v4, v9, v169
    v_mul_f32 v5, v9, v170
    v_mul_f32 v196, v9, v171
    v_exp_f32 v3, v3
    v_exp_f32 v4, v4
    v_mfma_f32_32x32x16_bf16 v[176:191], a[236:239], v[76:79], v[176:191]
    buffer_load_dwordx4 v[76:79], v2, s[56:59], s28 offen offset:3072 sc1
    ds_read_b64_tr_b16 a[228:229], v206 offset:36864
    ds_read_b64_tr_b16 a[230:231], v206 offset:37376
    v_exp_f32 v5, v5
    v_exp_f32 v196, v196
    v_fma_f32 v3, v3, v8, v8
    v_fma_f32 v4, v4, v8, v8
    s_waitcnt lgkmcnt(8)
    v_mfma_f32_32x32x16_bf16 v[176:191], a[240:243], v[80:83], v[176:191]
    s_add_u32 s28, s32, 237568
    buffer_load_dwordx4 v[80:83], v2, s[56:59], s28 offen offset:0 sc1
    ds_read_b64_tr_b16 a[232:233], v206 offset:40960
    ds_read_b64_tr_b16 a[234:235], v206 offset:41472
    v_fma_f32 v5, v5, v8, v8
    v_fma_f32 v196, v196, v8, v8
    v_rcp_f32 v3, v3
    v_rcp_f32 v4, v4
    v_mfma_f32_32x32x16_bf16 v[176:191], a[244:247], v[84:87], v[176:191]
    ds_read_b64_tr_b16 a[236:237], v206 offset:45056
    ds_read_b64_tr_b16 a[238:239], v206 offset:45568
    v_rcp_f32 v5, v5
    buffer_load_dwordx4 v[84:87], v2, s[56:59], s28 offen offset:1024 sc1
    v_rcp_f32 v196, v196
    s_waitcnt vmcnt(19)
    s_add_u32 s37, s25, 8192
    s_mov_b64 exec, 1
    buffer_store_dwordx2 v[254:255], v11, s[56:59], s37 offen sc1
    s_mov_b64 exec, -1
    v_mul_f32 v168, v168, v3
    v_mul_f32 v169, v169, v4
    v_mul_f32 v170, v170, v5
    s_waitcnt lgkmcnt(8)
    v_mfma_f32_32x32x16_bf16 v[176:191], a[248:251], v[88:91], v[176:191]
    ds_read_b64_tr_b16 a[240:241], v206 offset:34816
    ds_read_b64_tr_b16 a[242:243], v206 offset:35328
    v_mul_f32 v171, v171, v196
    buffer_load_dwordx4 v[88:91], v2, s[56:59], s28 offen offset:2048 sc1
    v_cvt_pk_bf16_f32 v164, v168, v169
    v_cvt_pk_bf16_f32 v165, v170, v171
    v_mul_f32 v3, v9, v172
    v_mfma_f32_32x32x16_bf16 v[176:191], a[252:255], v[92:95], v[176:191]
    ds_read_b64_tr_b16 a[244:245], v206 offset:38912
    ds_read_b64_tr_b16 a[246:247], v206 offset:39424
    v_mul_f32 v4, v9, v173
    v_mul_f32 v5, v9, v174
    s_mov_b32 s29, 0
    buffer_load_dwordx2 v[248:249], v14, s[56:59], s29 offen sc1
    v_mul_f32 v196, v9, v175
    v_exp_f32 v3, v3
    buffer_load_dwordx4 v[92:95], v2, s[56:59], s28 offen offset:3072 sc1
    s_waitcnt lgkmcnt(8)
    v_mfma_f32_32x32x16_bf16 v[176:191], a[224:227], v[96:99], v[176:191]
    ds_read_b64_tr_b16 a[248:249], v206 offset:43008
    ds_read_b64_tr_b16 a[250:251], v206 offset:43520
    v_exp_f32 v4, v4
    v_exp_f32 v5, v5
    v_exp_f32 v196, v196
    v_fma_f32 v3, v3, v8, v8
    v_fma_f32 v4, v4, v8, v8
    v_mfma_f32_32x32x16_bf16 v[176:191], a[228:231], v[100:103], v[176:191]
    ds_read_b64_tr_b16 a[252:253], v206 offset:47104
    s_add_u32 s28, s32, 241664
    buffer_load_dwordx4 v[96:99], v2, s[56:59], s28 offen offset:0 sc1
    ds_read_b64_tr_b16 a[254:255], v206 offset:47616
    v_fma_f32 v5, v5, v8, v8
    v_fma_f32 v196, v196, v8, v8
    v_rcp_f32 v3, v3
    v_rcp_f32 v4, v4
    s_waitcnt lgkmcnt(8)
    v_mfma_f32_32x32x16_bf16 v[176:191], a[232:235], v[104:107], v[176:191]
    v_rcp_f32 v5, v5
    v_rcp_f32 v196, v196
    v_mul_f32 v172, v172, v3
    buffer_load_dwordx4 v[100:103], v2, s[56:59], s28 offen offset:1024 sc1
    v_mul_f32 v173, v173, v4
    v_mfma_f32_32x32x16_bf16 v[176:191], a[236:239], v[108:111], v[176:191]
    v_mul_f32 v174, v174, v5
    v_mul_f32 v175, v175, v196
    v_cvt_pk_bf16_f32 v166, v172, v173
    v_cvt_pk_bf16_f32 v167, v174, v175
    buffer_store_dwordx4 v[164:167], v2, s[56:59], s101 offen offset:1024 sc1
    s_waitcnt lgkmcnt(4)
    v_mfma_f32_32x32x16_bf16 v[176:191], a[240:243], v[112:115], v[176:191]
    v_mfma_f32_32x32x16_bf16 v[176:191], a[244:247], v[116:119], v[176:191]
    buffer_load_dwordx4 v[104:107], v2, s[56:59], s28 offen offset:2048 sc1
    s_waitcnt lgkmcnt(0)
    v_mfma_f32_32x32x16_bf16 v[176:191], a[248:251], v[120:123], v[176:191]
    v_mfma_f32_32x32x16_bf16 v[176:191], a[252:255], v[124:127], v[176:191]
    buffer_load_dwordx4 v[108:111], v2, s[56:59], s28 offen offset:3072 sc1
    s_add_u32 s34, s33, 172032
    s_nop 9
    v_mul_f32 v3, v9, v176
    s_add_u32 s28, s32, 245760
    buffer_load_dwordx4 v[112:115], v2, s[56:59], s28 offen offset:0 sc1
    v_mul_f32 v4, v9, v177
    v_mul_f32 v5, v9, v178
    v_mul_f32 v196, v9, v179
    v_exp_f32 v3, v3
    v_exp_f32 v4, v4
    v_exp_f32 v5, v5
    v_exp_f32 v196, v196
    v_fma_f32 v3, v3, v8, v8
    v_fma_f32 v4, v4, v8, v8
    v_fma_f32 v5, v5, v8, v8
    v_fma_f32 v196, v196, v8, v8
    buffer_load_dwordx4 v[116:119], v2, s[56:59], s28 offen offset:1024 sc1
    v_rcp_f32 v3, v3
    v_rcp_f32 v4, v4
    v_rcp_f32 v5, v5
    v_rcp_f32 v196, v196
    v_mul_f32 v176, v176, v3
    v_mul_f32 v177, v177, v4
    v_mul_f32 v178, v178, v5
    v_mul_f32 v179, v179, v196
    v_cvt_pk_bf16_f32 v176, v176, v177
    v_cvt_pk_bf16_f32 v177, v178, v179
    v_mul_f32 v3, v9, v180
    v_mul_f32 v4, v9, v181
    v_mul_f32 v5, v9, v182
    v_mul_f32 v196, v9, v183
    buffer_load_dwordx4 v[120:123], v2, s[56:59], s28 offen offset:2048 sc1
    v_exp_f32 v3, v3
    v_exp_f32 v4, v4
    v_exp_f32 v5, v5
    v_exp_f32 v196, v196
    v_fma_f32 v3, v3, v8, v8
    v_fma_f32 v4, v4, v8, v8
    v_fma_f32 v5, v5, v8, v8
    v_fma_f32 v196, v196, v8, v8
    v_rcp_f32 v3, v3
    v_rcp_f32 v4, v4
    v_rcp_f32 v5, v5
    buffer_load_dwordx4 v[124:127], v2, s[56:59], s28 offen offset:3072 sc1
    v_rcp_f32 v196, v196
    v_mul_f32 v180, v180, v3
    v_mul_f32 v181, v181, v4
    v_mul_f32 v182, v182, v5
    v_mul_f32 v183, v183, v196
    v_cvt_pk_bf16_f32 v178, v180, v181
    v_cvt_pk_bf16_f32 v179, v182, v183
    s_add_u32 s101, s16, 86016
    buffer_store_dwordx4 v[176:179], v2, s[56:59], s101 offen sc1
    v_mul_f32 v3, v9, v184
    v_mul_f32 v4, v9, v185
    v_mul_f32 v5, v9, v186
    v_mul_f32 v196, v9, v187
    v_exp_f32 v3, v3
    v_exp_f32 v4, v4
    v_exp_f32 v5, v5
    v_exp_f32 v196, v196
    v_fma_f32 v3, v3, v8, v8
    v_fma_f32 v4, v4, v8, v8
    v_fma_f32 v5, v5, v8, v8
    v_fma_f32 v196, v196, v8, v8
    v_rcp_f32 v3, v3
    v_rcp_f32 v4, v4
    v_rcp_f32 v5, v5
    v_rcp_f32 v196, v196
    v_mul_f32 v184, v184, v3
    v_mul_f32 v185, v185, v4
    v_mul_f32 v186, v186, v5
    v_mul_f32 v187, v187, v196
    v_cvt_pk_bf16_f32 v180, v184, v185
    v_cvt_pk_bf16_f32 v181, v186, v187
    v_mul_f32 v3, v9, v188
    v_mul_f32 v4, v9, v189
    v_mul_f32 v5, v9, v190
    v_mul_f32 v196, v9, v191
    v_exp_f32 v3, v3
    v_exp_f32 v4, v4
    v_exp_f32 v5, v5
    v_exp_f32 v196, v196
    v_fma_f32 v3, v3, v8, v8
    v_fma_f32 v4, v4, v8, v8
    v_fma_f32 v5, v5, v8, v8
    v_fma_f32 v196, v196, v8, v8
    v_rcp_f32 v3, v3
    s_waitcnt vmcnt(11)
    v_cmp_ne_u32 vcc, s12, v248
    v_cmp_ne_u32 s[30:31], s13, v249
    s_nop 1
    s_or_b32 s37, vcc_lo, s30
    s_and_b32 s37, s37, s20
    s_cbranch_scc1 L_retry_f0
L_ok_f0:
    v_rcp_f32 v4, v4
    s_add_u32 s26, s22, 0
    buffer_load_dwordx4 a[224:227], v2, s[56:59], s26 offen offset:0 sc1
    v_rcp_f32 v5, v5
    v_rcp_f32 v196, v196
    v_mul_f32 v188, v188, v3
    v_mul_f32 v189, v189, v4
    v_mul_f32 v190, v190, v5
    v_mul_f32 v191, v191, v196
    v_cvt_pk_bf16_f32 v182, v188, v189
    v_cvt_pk_bf16_f32 v183, v190, v191
    s_add_u32 s27, s23, 0
    buffer_load_dwordx4 a[228:231], v2, s[56:59], s27 offen offset:0 sc1
    buffer_store_dwordx4 v[180:183], v2, s[56:59], s101 offen offset:1024 sc1
    v_sub_u32 v6, s8, v12
    v_add_u32 v6, 1, v6
    v_lshrrev_b32 v6, 1, v6
    v_mul_lo_u32 v5, s12, v6
    v_mul_lo_u32 v6, s13, v6
    v_add3_u32 v3, v18, v22, v26
    v_add3_u32 v4, v19, v23, v27
    v_add3_u32 v3, v3, v30, v34
    v_add3_u32 v4, v4, v31, v35
    v_add3_u32 v3, v3, v38, v42
    v_add3_u32 v4, v4, v39, v43
    v_add_u32 v3, v3, v46
    v_add_u32 v4, v4, v47
    buffer_load_dwordx4 a[232:235], v2, s[56:59], s26 offen offset:1024 sc1
    v_cmp_ne_u32 vcc, v3, v5
    v_cmp_ne_u32 s[30:31], v4, v6
    s_nop 1
    s_or_b64 vcc, vcc, s[30:31]
    s_cbranch_scc1 L_retry_lb
L_ok_lb:
    v_fmac_f32 v40, v220, v44
    v_fmac_f32 v41, v220, v45
    v_fma_f32 v40, -v221, v45, v40
    v_fmac_f32 v41, v221, v44
    v_fmac_f32 v36, v220, v40
    v_fmac_f32 v37, v220, v41
    v_fma_f32 v36, -v221, v41, v36
    v_fmac_f32 v37, v221, v40
    v_fmac_f32 v32, v220, v36
    v_fmac_f32 v33, v220, v37
    v_fma_f32 v32, -v221, v37, v32
    buffer_load_dwordx4 a[236:239], v2, s[56:59], s27 offen offset:1024 sc1
    v_fmac_f32 v33, v221, v36
    v_fmac_f32 v28, v220, v32
    v_fmac_f32 v29, v220, v33
    v_fma_f32 v28, -v221, v33, v28
    v_fmac_f32 v29, v221, v32
    v_fmac_f32 v24, v220, v28
    v_fmac_f32 v25, v220, v29
    v_fma_f32 v24, -v221, v29, v24
    v_fmac_f32 v25, v221, v28
    v_fmac_f32 v20, v220, v24
    v_fmac_f32 v21, v220, v25
    v_fma_f32 v20, -v221, v25, v20
    v_fmac_f32 v21, v221, v24
    v_fmac_f32 v16, v220, v20
    v_fmac_f32 v17, v220, v21
    v_fma_f32 v16, -v221, v21, v16
    v_fmac_f32 v17, v221, v20
    buffer_load_dwordx4 a[240:243], v2, s[56:59], s26 offen offset:2048 sc1
    v_mov_b32 v20, v16
    v_mov_b32 v21, v17
    s_nop 0
    v_permlane32_swap_b32 v16, v20
    v_permlane32_swap_b32 v17, v21
    v_fmac_f32 v16, v218, v20
    v_fmac_f32 v17, v218, v21
    v_fma_f32 v16, -v219, v21, v16
    v_fmac_f32 v17, v219, v20
    v_fmac_f32 v224, v216, v16
    v_fmac_f32 v225, v216, v17
    v_fma_f32 v224, -v217, v17, v224
    v_fmac_f32 v225, v217, v16
    v_fmac_f32 v226, v216, v224
    v_fmac_f32 v227, v216, v225
    v_fma_f32 v226, -v217, v225, v226
    v_fmac_f32 v227, v217, v224
    v_fmac_f32 v228, v216, v226
    buffer_load_dwordx4 a[244:247], v2, s[56:59], s27 offen offset:2048 sc1
    v_fmac_f32 v229, v216, v227
    v_fma_f32 v228, -v217, v227, v228
    v_fmac_f32 v229, v217, v226
    v_mov_b32 v24, v16
    v_mov_b32 v25, v17
    s_cmp_eq_u32 s10, 1
    s_cselect_b64 vcc, -1, 0
    v_cndmask_b32 v24, v24, v224, vcc
    v_cndmask_b32 v25, v25, v225, vcc
    s_cmp_eq_u32 s10, 2
    s_cselect_b64 vcc, -1, 0
    v_cndmask_b32 v24, v24, v226, vcc
    v_cndmask_b32 v25, v25, v227, vcc
    s_cmp_eq_u32 s10, 3
    s_cselect_b64 vcc, -1, 0
    v_cndmask_b32 v24, v24, v228, vcc
    v_cndmask_b32 v25, v25, v229, vcc
    v_fma_f32 v26, v214, v24, v232
    buffer_load_dwordx4 a[248:251], v2, s[56:59], s26 offen offset:3072 sc1
    v_fma_f32 v27, v214, v25, v234
    v_fma_f32 v26, -v215, v25, v26
    v_fmac_f32 v27, v215, v24
    v_fma_f32 v28, v214, v26, v233
    v_fma_f32 v29, v214, v27, v235
    v_fma_f32 v28, -v215, v27, v28
    v_fmac_f32 v29, v215, v26
    v_fma_f32 v30, v214, v28, v236
    v_fma_f32 v31, v214, v29, v238
    v_fma_f32 v30, -v215, v29, v30
    v_fmac_f32 v31, v215, v28
    v_fma_f32 v32, v214, v30, v237
    v_fma_f32 v33, v214, v31, v239
    v_fma_f32 v32, -v215, v31, v32
    v_fmac_f32 v33, v215, v30
    buffer_load_dwordx4 a[252:255], v2, s[56:59], s27 offen offset:3072 sc1
    v_fma_f32 v34, v214, v32, v240
    v_fma_f32 v35, v214, v33, v242
    v_fma_f32 v34, -v215, v33, v34
    v_fmac_f32 v35, v215, v32
    v_fma_f32 v36, v214, v34, v241
    v_fma_f32 v37, v214, v35, v243
    v_fma_f32 v36, -v215, v35, v36
    v_fmac_f32 v37, v215, v34
    v_fma_f32 v38, v214, v36, v244
    v_fma_f32 v39, v214, v37, v246
    v_fma_f32 v38, -v215, v37, v38
    v_fmac_f32 v39, v215, v36
    s_mov_b32 vcc_lo, 0
    s_mov_b32 vcc_hi, -1
    v_cndmask_b32 v24, v24, v26, vcc
    v_cndmask_b32 v25, v25, v27, vcc
    v_cndmask_b32 v28, v28, v30, vcc
    v_cndmask_b32 v29, v29, v31, vcc
    v_cndmask_b32 v32, v32, v34, vcc
    v_cndmask_b32 v33, v33, v35, vcc
    v_cndmask_b32 v36, v36, v38, vcc
    v_cndmask_b32 v37, v37, v39, vcc
    s_add_u32 s26, s22, 4096
    buffer_load_dwordx4 v[160:163], v2, s[56:59], s26 offen offset:0 sc1
    v_sub_f32 v26, 0, v25
    v_sub_f32 v30, 0, v29
    v_sub_f32 v34, 0, v33
    v_sub_f32 v38, 0, v37
    v_lshrrev_b32 v3, 4, v1
    v_and_b32 v4, 15, v1
    v_mul_u32_u24 v5, 896, v3
    v_lshl_add_u32 v5, v4, 3, v5
    s_lshl_b32 s38, s19, 5
    s_lshl_b32 s99, s10, 4
    s_add_u32 s38, s38, s99
    s_add_u32 s27, s23, 4096
    buffer_load_dwordx4 v[164:167], v2, s[56:59], s27 offen offset:0 sc1
    s_mul_i32 s38, s38, 896
    s_lshl_b32 s99, s17, 7
    s_add_u32 s38, s38, s99
    s_add_u32 s98, s38, 7168
    buffer_load_dwordx2 v[224:225], v5, s[40:43], s38 offen offset:0
    buffer_load_dwordx2 v[226:227], v5, s[40:43], s38 offen offset:3584
    buffer_load_dwordx2 v[228:229], v5, s[40:43], s98 offen offset:0
    buffer_load_dwordx2 v[230:231], v5, s[40:43], s98 offen offset:3584
    v_lshlrev_b32 v6, 3, v4
    buffer_load_dwordx2 v[232:233], v6, s[76:79], s99 offen
    s_mov_b32 s29, 8192
    buffer_load_dwordx2 v[248:249], v14, s[56:59], s29 offen sc1
    s_lshl_b32 s99, s18, 9
    buffer_load_dwordx4 v[168:171], v2, s[56:59], s26 offen offset:1024 sc1
    s_lshl_b32 s98, s10, 7
    s_add_u32 s99, s99, s98
    v_lshl_add_u32 v6, v3, 3, s99
    ds_read_b64 v[234:235], v6 offset:512
    ds_read_b64 v[236:237], v6 offset:544
    ds_read_b64 v[238:239], v6 offset:576
    ds_read_b64 v[240:241], v6 offset:608
    v_fmac_f32 v128, v207, v24
    v_fmac_f32 v144, v207, v25
    v_fmac_f32 v128, v208, v26
    v_fmac_f32 v144, v208, v24
    v_fmac_f32 v129, v210, v24
    v_fmac_f32 v145, v210, v25
    v_fmac_f32 v129, v211, v26
    v_fmac_f32 v145, v211, v24
    buffer_load_dwordx4 v[172:175], v2, s[56:59], s27 offen offset:1024 sc1
    v_fmac_f32 v130, v212, v24
    s_waitcnt vmcnt(26)
    s_add_u32 s37, s25, 16384
    s_mov_b64 exec, 1
    buffer_store_dwordx2 v[254:255], v11, s[56:59], s37 offen sc1
    s_mov_b64 exec, -1
    v_fmac_f32 v146, v212, v25
    v_fmac_f32 v130, v213, v26
    v_fmac_f32 v146, v213, v24
    v_fmac_f32 v131, v214, v24
    v_fmac_f32 v147, v214, v25
    v_fmac_f32 v131, v215, v26
    v_fmac_f32 v147, v215, v24
    v_cvt_pk_bf16_f32 v128, v128, v129
    v_cvt_pk_bf16_f32 v129, v130, v131
    ds_write_b64 v222, v[128:129] offset:0
    v_cvt_pk_bf16_f32 v144, v144, v145
    v_cvt_pk_bf16_f32 v145, v146, v147
    ds_write_b64 v222, v[144:145] offset:2304
    v_fmac_f32 v132, v207, v28
    v_fmac_f32 v148, v207, v29
    v_fmac_f32 v132, v208, v30
    v_fmac_f32 v148, v208, v28
    v_fmac_f32 v133, v210, v28
    v_fmac_f32 v149, v210, v29
    v_fmac_f32 v133, v211, v30
    v_fmac_f32 v149, v211, v28
    v_fmac_f32 v134, v212, v28
    v_fmac_f32 v150, v212, v29
    v_fmac_f32 v134, v213, v30
    v_fmac_f32 v150, v213, v28
    v_fmac_f32 v135, v214, v28
    v_fmac_f32 v151, v214, v29
    v_fmac_f32 v135, v215, v30
    v_fmac_f32 v151, v215, v28
    v_cvt_pk_bf16_f32 v132, v132, v133
    v_cvt_pk_bf16_f32 v133, v134, v135
    ds_write_b64 v222, v[132:133] offset:16
    v_cvt_pk_bf16_f32 v148, v148, v149
    v_cvt_pk_bf16_f32 v149, v150, v151
    ds_write_b64 v222, v[148:149] offset:2320
    v_fmac_f32 v136, v207, v32
    v_fmac_f32 v152, v207, v33
    v_fmac_f32 v136, v208, v34
    v_fmac_f32 v152, v208, v32
    v_fmac_f32 v137, v210, v32
    v_fmac_f32 v153, v210, v33
    v_fmac_f32 v137, v211, v34
    v_fmac_f32 v153, v211, v32
    v_fmac_f32 v138, v212, v32
    v_fmac_f32 v154, v212, v33
    v_fmac_f32 v138, v213, v34
    v_fmac_f32 v154, v213, v32
    v_fmac_f32 v139, v214, v32
    v_fmac_f32 v155, v214, v33
    v_fmac_f32 v139, v215, v34
    v_fmac_f32 v155, v215, v32
    v_cvt_pk_bf16_f32 v136, v136, v137
    v_cvt_pk_bf16_f32 v137, v138, v139
    ds_write_b64 v222, v[136:137] offset:32
    v_cvt_pk_bf16_f32 v152, v152, v153
    v_cvt_pk_bf16_f32 v153, v154, v155
    ds_write_b64 v222, v[152:153] offset:2336
    v_fmac_f32 v140, v207, v36
    v_fmac_f32 v156, v207, v37
    v_fmac_f32 v140, v208, v38
    v_fmac_f32 v156, v208, v36
    v_fmac_f32 v141, v210, v36
    v_fmac_f32 v157, v210, v37
    v_fmac_f32 v141, v211, v38
    v_fmac_f32 v157, v211, v36
    v_fmac_f32 v142, v212, v36
    v_fmac_f32 v158, v212, v37
    v_fmac_f32 v142, v213, v38
    v_fmac_f32 v158, v213, v36
    v_fmac_f32 v143, v214, v36
    v_fmac_f32 v159, v214, v37
    v_fmac_f32 v143, v215, v38
    v_fmac_f32 v159, v215, v36
    v_cvt_pk_bf16_f32 v140, v140, v141
    v_cvt_pk_bf16_f32 v141, v142, v143
    ds_write_b64 v222, v[140:141] offset:48
    v_cvt_pk_bf16_f32 v156, v156, v157
    v_cvt_pk_bf16_f32 v157, v158, v159
    ds_write_b64 v222, v[156:157] offset:2352
    ds_read_b64_tr_b16 v[176:177], v223 offset:0
    ds_read_b64_tr_b16 v[178:179], v223 offset:288
    ds_read_b64_tr_b16 v[180:181], v223 offset:1152
    ds_read_b64_tr_b16 v[182:183], v223 offset:1440
    ds_read_b64_tr_b16 v[184:185], v223 offset:2304
    ds_read_b64_tr_b16 v[186:187], v223 offset:2592
    ds_read_b64_tr_b16 v[188:189], v223 offset:3456
    ds_read_b64_tr_b16 v[190:191], v223 offset:3744
    s_lshl_b32 s101, s9, 11
    s_add_u32 s101, s101, s16
    s_add_u32 s101, s101, 114688
    s_waitcnt lgkmcnt(6)
    buffer_store_dwordx4 v[176:179], v2, s[56:59], s101 offen offset:0 sc1
    s_waitcnt lgkmcnt(4)
    buffer_store_dwordx4 v[180:183], v2, s[56:59], s101 offen offset:1024 sc1
    s_waitcnt lgkmcnt(2)
    buffer_store_dwordx4 v[184:187], v2, s[56:59], s101 offen offset:2048 sc1
    s_waitcnt lgkmcnt(0)
    buffer_store_dwordx4 v[188:191], v2, s[56:59], s101 offen offset:3072 sc1
    s_waitcnt vmcnt(23)
    v_mfma_f32_32x32x16_bf16 v[128:143], a[0:3], a[224:227], 0
    s_waitcnt vmcnt(21)
    s_add_u32 s37, s25, 24576
    s_mov_b64 exec, 1
    buffer_store_dwordx2 v[254:255], v11, s[56:59], s37 offen sc1
    s_mov_b64 exec, -1
    v_mfma_f32_32x32x16_bf16 v[144:159], a[0:3], a[228:231], 0
    buffer_load_dwordx4 v[176:179], v2, s[56:59], s26 offen offset:2048 sc1
    v_mfma_f32_32x32x16_bf16 v[192:207], a[4:7], a[224:227], 0
    buffer_load_dwordx4 v[180:183], v2, s[56:59], s27 offen offset:2048 sc1
    v_mfma_f32_32x32x16_bf16 v[208:223], a[4:7], a[228:231], 0
    s_waitcnt vmcnt(23)
    v_mfma_f32_32x32x16_bf16 v[128:143], a[8:11], a[232:235], v[128:143]
    v_lshlrev_b32 v46, 1, v5
    s_lshl_b32 s39, s38, 1
    v_and_b32 v40, 7, v13
    v_xor_b32 v40, v40, v12
    v_lshlrev_b32 v40, 4, v40
    v_lshl_add_u32 v40, v13, 8, v40
    v_add_u32 v40, s100, v40
    v_xor_b32 v41, 32, v40
    v_xor_b32 v42, 64, v40
    s_waitcnt vmcnt(22)
    v_mfma_f32_32x32x16_bf16 v[144:159], a[8:11], a[236:239], v[144:159]
    v_xor_b32 v43, 96, v40
    v_xor_b32 v44, v4, v3
    v_lshlrev_b32 v44, 4, v44
    v_lshl_add_u32 v44, v3, 8, v44
    s_lshl_b32 s99, s10, 12
    s_add_u32 s99, s99, 8192
    v_add_u32 v44, s99, v44
    v_xor_b32 v45, 64, v44
    v_add_u32 v45, 1024, v45
    v_mfma_f32_32x32x16_bf16 v[192:207], a[12:15], a[232:235], v[192:207]
    v_add_u32 v38, 73728, v44
    v_add_u32 v39, 73728, v45
    s_waitcnt vmcnt(11)
    v_lshlrev_b32 v242, 16, v232
    v_and_b32 v243, s15, v232
    v_lshlrev_b32 v244, 16, v233
    v_and_b32 v245, s15, v233
    v_lshlrev_b32 v16, 16, v224
    v_and_b32 v17, s15, v224
    v_lshlrev_b32 v18, 16, v225
    v_mfma_f32_32x32x16_bf16 v[208:223], a[12:15], a[236:239], v[208:223]
    v_and_b32 v19, s15, v225
    v_sub_f32 v32, v16, v234
    v_sub_f32 v33, v17, v234
    v_sub_f32 v34, v18, v234
    v_sub_f32 v35, v19, v234
    v_cvt_pk_bf16_f32 v36, v32, v33
    v_cvt_pk_bf16_f32 v37, v34, v35
    v_lshlrev_b32 v32, 16, v36
    v_and_b32 v33, s15, v36
    v_mfma_f32_32x32x16_bf16 v[128:143], a[16:19], a[240:243], v[128:143]
    s_waitcnt vmcnt(10)
    v_cmp_ne_u32 vcc, s12, v248
    v_cmp_ne_u32 s[30:31], s13, v249
    s_nop 1
    s_or_b32 s37, vcc_lo, s30
    s_and_b32 s37, s37, s20
    s_cbranch_scc1 L_retry_f1
L_ok_f1:
    s_add_u32 s26, s22, 28672
    buffer_load_dwordx4 v[184:187], v2, s[56:59], s26 offen offset:0 sc1
    v_mfma_f32_32x32x16_bf16 v[144:159], a[16:19], a[244:247], v[144:159]
    s_add_u32 s27, s23, 28672
    buffer_load_dwordx4 v[188:191], v2, s[56:59], s27 offen offset:0 sc1
    v_lshlrev_b32 v34, 16, v37
    v_and_b32 v35, s15, v37
    v_mul_f32 v32, v32, v235
    v_mul_f32 v33, v33, v235
    v_mul_f32 v34, v34, v235
    v_mul_f32 v35, v35, v235
    v_mfma_f32_32x32x16_bf16 v[192:207], a[20:23], a[240:243], v[192:207]
    buffer_load_dwordx4 a[0:3], v2, s[56:59], s26 offen offset:1024 sc1
    v_cvt_pk_bf16_f32 v36, v32, v33
    v_cvt_pk_bf16_f32 v37, v34, v35
    v_lshlrev_b32 v32, 16, v36
    v_and_b32 v33, s15, v36
    v_lshlrev_b32 v34, 16, v37
    v_and_b32 v35, s15, v37
    v_mul_f32 v32, v32, v242
    v_mfma_f32_32x32x16_bf16 v[208:223], a[20:23], a[244:247], v[208:223]
    buffer_load_dwordx4 a[4:7], v2, s[56:59], s27 offen offset:1024 sc1
    v_mul_f32 v33, v33, v243
    v_mul_f32 v34, v34, v244
    v_mul_f32 v35, v35, v245
    v_cvt_pk_bf16_f32 v36, v32, v33
    v_cvt_pk_bf16_f32 v37, v34, v35
    v_lshlrev_b32 v32, 16, v36
    v_and_b32 v33, s15, v36
    v_mfma_f32_32x32x16_bf16 v[128:143], a[24:27], a[248:251], v[128:143]
    s_mov_b32 s29, 16384
    buffer_load_dwordx2 v[248:249], v14, s[56:59], s29 offen sc1
    v_lshlrev_b32 v34, 16, v37
    v_and_b32 v35, s15, v37
    v_add_f32 v16, v16, v32
    v_add_f32 v17, v17, v33
    v_add_f32 v18, v18, v34
    v_add_f32 v19, v19, v35
    v_mfma_f32_32x32x16_bf16 v[144:159], a[24:27], a[252:255], v[144:159]
    buffer_load_dwordx4 a[224:227], v2, s[56:59], s26 offen offset:2048 sc1
    v_lshlrev_b32 v20, 16, v226
    v_and_b32 v21, s15, v226
    v_lshlrev_b32 v22, 16, v227
    v_and_b32 v23, s15, v227
    v_sub_f32 v32, v20, v236
    v_sub_f32 v33, v21, v236
    v_sub_f32 v34, v22, v236
    v_mfma_f32_32x32x16_bf16 v[192:207], a[28:31], a[248:251], v[192:207]
    buffer_load_dwordx4 a[228:231], v2, s[56:59], s27 offen offset:2048 sc1
    v_sub_f32 v35, v23, v236
    v_cvt_pk_bf16_f32 v36, v32, v33
    v_cvt_pk_bf16_f32 v37, v34, v35
    v_lshlrev_b32 v32, 16, v36
    v_and_b32 v33, s15, v36
    v_lshlrev_b32 v34, 16, v37
    v_and_b32 v35, s15, v37
    v_mfma_f32_32x32x16_bf16 v[208:223], a[28:31], a[252:255], v[208:223]
    v_mul_f32 v32, v32, v237
    v_mul_f32 v33, v33, v237
    v_mul_f32 v34, v34, v237
    v_mul_f32 v35, v35, v237
    v_cvt_pk_bf16_f32 v36, v32, v33
    v_cvt_pk_bf16_f32 v37, v34, v35
    v_lshlrev_b32 v32, 16, v36
    v_and_b32 v33, s15, v36
    v_lshlrev_b32 v34, 16, v37
    v_mfma_f32_32x32x16_bf16 v[128:143], a[32:35], v[160:163], v[128:143]
    buffer_load_dwordx4 a[8:11], v2, s[56:59], s26 offen offset:3072 sc1
    v_and_b32 v35, s15, v37
    v_mul_f32 v32, v32, v242
    v_mul_f32 v33, v33, v243
    v_mul_f32 v34, v34, v244
    v_mul_f32 v35, v35, v245
    v_cvt_pk_bf16_f32 v36, v32, v33
    v_cvt_pk_bf16_f32 v37, v34, v35
    v_mfma_f32_32x32x16_bf16 v[144:159], a[32:35], v[164:167], v[144:159]
    v_lshlrev_b32 v32, 16, v36
    v_and_b32 v33, s15, v36
    v_lshlrev_b32 v34, 16, v37
    v_and_b32 v35, s15, v37
    v_add_f32 v20, v20, v32
    v_add_f32 v21, v21, v33
    v_add_f32 v22, v22, v34
    v_add_f32 v23, v23, v35
    v_lshlrev_b32 v24, 16, v228
    v_mfma_f32_32x32x16_bf16 v[192:207], a[36:39], v[160:163], v[192:207]
    buffer_load_dwordx4 a[12:15], v2, s[56:59], s27 offen offset:3072 sc1
    v_and_b32 v25, s15, v228
    v_lshlrev_b32 v26, 16, v229
    v_and_b32 v27, s15, v229
    v_sub_f32 v32, v24, v238
    v_sub_f32 v33, v25, v238
    v_sub_f32 v34, v26, v238
    v_sub_f32 v35, v27, v238
    v_mfma_f32_32x32x16_bf16 v[208:223], a[36:39], v[164:167], v[208:223]
    v_cvt_pk_bf16_f32 v36, v32, v33
    v_cvt_pk_bf16_f32 v37, v34, v35
    v_lshlrev_b32 v32, 16, v36
    v_and_b32 v33, s15, v36
    v_lshlrev_b32 v34, 16, v37
    v_and_b32 v35, s15, v37
    v_mul_f32 v32, v32, v239
    v_mul_f32 v33, v33, v239
    v_mul_f32 v34, v34, v239
    s_waitcnt vmcnt(18)
    v_mfma_f32_32x32x16_bf16 v[128:143], a[40:43], v[168:171], v[128:143]
    s_add_u32 s26, s22, 32768
    buffer_load_dwordx4 a[232:235], v2, s[56:59], s26 offen offset:0 sc1
    v_mul_f32 v35, v35, v239
    v_cvt_pk_bf16_f32 v36, v32, v33
    v_cvt_pk_bf16_f32 v37, v34, v35
    v_lshlrev_b32 v32, 16, v36
    v_and_b32 v33, s15, v36
    v_lshlrev_b32 v34, 16, v37
    s_waitcnt vmcnt(18)
    v_mfma_f32_32x32x16_bf16 v[144:159], a[40:43], v[172:175], v[144:159]
    v_and_b32 v35, s15, v37
    v_mul_f32 v32, v32, v242
    v_mul_f32 v33, v33, v243
    v_mul_f32 v34, v34, v244
    v_mul_f32 v35, v35, v245
    v_cvt_pk_bf16_f32 v36, v32, v33
    v_cvt_pk_bf16_f32 v37, v34, v35
    v_lshlrev_b32 v32, 16, v36
    v_and_b32 v33, s15, v36
    v_mfma_f32_32x32x16_bf16 v[192:207], a[44:47], v[168:171], v[192:207]
    s_add_u32 s27, s23, 32768
    buffer_load_dwordx4 a[236:239], v2, s[56:59], s27 offen offset:0 sc1
    v_lshlrev_b32 v34, 16, v37
    v_and_b32 v35, s15, v37
    v_add_f32 v24, v24, v32
    v_add_f32 v25, v25, v33
    v_add_f32 v26, v26, v34
    v_add_f32 v27, v27, v35
    v_mfma_f32_32x32x16_bf16 v[208:223], a[44:47], v[172:175], v[208:223]
    v_lshlrev_b32 v28, 16, v230
    v_and_b32 v29, s15, v230
    v_lshlrev_b32 v30, 16, v231
    v_and_b32 v31, s15, v231
    v_sub_f32 v32, v28, v240
    v_sub_f32 v33, v29, v240
    v_sub_f32 v34, v30, v240
    v_sub_f32 v35, v31, v240
    v_cvt_pk_bf16_f32 v36, v32, v33
    s_waitcnt vmcnt(12)
    v_mfma_f32_32x32x16_bf16 v[128:143], a[48:51], v[176:179], v[128:143]
    buffer_load_dwordx4 a[16:19], v2, s[56:59], s26 offen offset:1024 sc1
    v_cvt_pk_bf16_f32 v37, v34, v35
    v_lshlrev_b32 v32, 16, v36
    v_and_b32 v33, s15, v36
    v_lshlrev_b32 v34, 16, v37
    v_and_b32 v35, s15, v37
    v_mul_f32 v32, v32, v241
    v_mul_f32 v33, v33, v241
    s_waitcnt vmcnt(12)
    v_mfma_f32_32x32x16_bf16 v[144:159], a[48:51], v[180:183], v[144:159]
    v_mul_f32 v34, v34, v241
    v_mul_f32 v35, v35, v241
    v_cvt_pk_bf16_f32 v36, v32, v33
    v_cvt_pk_bf16_f32 v37, v34, v35
    v_lshlrev_b32 v32, 16, v36
    v_and_b32 v33, s15, v36
    v_lshlrev_b32 v34, 16, v37
    v_and_b32 v35, s15, v37
    v_mul_f32 v32, v32, v242
    v_mfma_f32_32x32x16_bf16 v[192:207], a[52:55], v[176:179], v[192:207]
    buffer_load_dwordx4 a[20:23], v2, s[56:59], s27 offen offset:1024 sc1
    v_mul_f32 v33, v33, v243
    v_mul_f32 v34, v34, v244
    v_mul_f32 v35, v35, v245
    v_cvt_pk_bf16_f32 v36, v32, v33
    v_cvt_pk_bf16_f32 v37, v34, v35
    v_lshlrev_b32 v32, 16, v36
    v_and_b32 v33, s15, v36
    v_mfma_f32_32x32x16_bf16 v[208:223], a[52:55], v[180:183], v[208:223]
    v_lshlrev_b32 v34, 16, v37
    v_and_b32 v35, s15, v37
    v_add_f32 v28, v28, v32
    v_add_f32 v29, v29, v33
    v_add_f32 v30, v30, v34
    v_add_f32 v31, v31, v35
    s_waitcnt vmcnt(12)
    v_mfma_f32_32x32x16_bf16 v[128:143], a[56:59], v[184:187], v[128:143]
    s_add_u32 s37, s25, 32768
    s_mov_b64 exec, 1
    buffer_store_dwordx2 v[254:255], v11, s[56:59], s37 offen sc1
    s_mov_b64 exec, -1
    s_waitcnt vmcnt(12)
    v_mfma_f32_32x32x16_bf16 v[144:159], a[56:59], v[188:191], v[144:159]
    buffer_load_dwordx4 a[240:243], v2, s[56:59], s26 offen offset:2048 sc1
    v_mfma_f32_32x32x16_bf16 v[192:207], a[60:63], v[184:187], v[192:207]
    buffer_load_dwordx4 a[244:247], v2, s[56:59], s27 offen offset:2048 sc1
    v_mfma_f32_32x32x16_bf16 v[208:223], a[60:63], v[188:191], v[208:223]
    s_waitcnt vmcnt(13)
    v_mfma_f32_32x32x16_bf16 v[128:143], a[64:67], a[0:3], v[128:143]
    s_waitcnt vmcnt(12)
    v_mfma_f32_32x32x16_bf16 v[144:159], a[64:67], a[4:7], v[144:159]
    v_mfma_f32_32x32x16_bf16 v[192:207], a[68:71], a[0:3], v[192:207]
    v_mfma_f32_32x32x16_bf16 v[208:223], a[68:71], a[4:7], v[208:223]
    s_waitcnt vmcnt(10)
    v_mfma_f32_32x32x16_bf16 v[128:143], a[72:75], a[224:227], v[128:143]
    v_cmp_ne_u32 vcc, s12, v248
    v_cmp_ne_u32 s[30:31], s13, v249
    s_nop 1
    s_or_b32 s37, vcc_lo, s30
    s_and_b32 s37, s37, s20
    s_cbranch_scc1 L_retry_f2
L_ok_f2:
    s_mov_b32 s29, 24576
    buffer_load_dwordx2 v[248:249], v14, s[56:59], s29 offen sc1
    s_waitcnt vmcnt(10)
    v_mfma_f32_32x32x16_bf16 v[144:159], a[72:75], a[228:231], v[144:159]
    s_add_u32 s26, s22, 57344
    buffer_load_dwordx4 a[24:27], v2, s[56:59], s26 offen offset:0 sc1
    v_mfma_f32_32x32x16_bf16 v[192:207], a[76:79], a[224:227], v[192:207]
    s_add_u32 s27, s23, 57344
    buffer_load_dwordx4 a[28:31], v2, s[56:59], s27 offen offset:0 sc1
    buffer_load_dwordx4 a[248:251], v2, s[56:59], s26 offen offset:1024 sc1
    v_mfma_f32_32x32x16_bf16 v[208:223], a[76:79], a[228:231], v[208:223]
    buffer_load_dwordx4 a[252:255], v2, s[56:59], s27 offen offset:1024 sc1
    s_waitcnt vmcnt(13)
    v_mfma_f32_32x32x16_bf16 v[128:143], a[80:83], a[8:11], v[128:143]
    buffer_load_dwordx4 a[32:35], v2, s[56:59], s26 offen offset:2048 sc1
    s_waitcnt vmcnt(13)
    v_mfma_f32_32x32x16_bf16 v[144:159], a[80:83], a[12:15], v[144:159]
    v_mfma_f32_32x32x16_bf16 v[192:207], a[84:87], a[8:11], v[192:207]
    buffer_load_dwordx4 a[36:39], v2, s[56:59], s27 offen offset:2048 sc1
    v_mfma_f32_32x32x16_bf16 v[208:223], a[84:87], a[12:15], v[208:223]
    s_waitcnt vmcnt(13)
    v_mfma_f32_32x32x16_bf16 v[128:143], a[88:91], a[232:235], v[128:143]
    buffer_load_dwordx4 v[160:163], v2, s[56:59], s26 offen offset:3072 sc1
    s_waitcnt vmcnt(13)
    v_mfma_f32_32x32x16_bf16 v[144:159], a[88:91], a[236:239], v[144:159]
    v_mfma_f32_32x32x16_bf16 v[192:207], a[92:95], a[232:235], v[192:207]
    buffer_load_dwordx4 v[164:167], v2, s[56:59], s27 offen offset:3072 sc1
    v_mfma_f32_32x32x16_bf16 v[208:223], a[92:95], a[236:239], v[208:223]
    s_waitcnt vmcnt(13)
    v_mfma_f32_32x32x16_bf16 v[128:143], a[96:99], a[16:19], v[128:143]
    s_add_u32 s26, s22, 61440
    buffer_load_dwordx4 a[40:43], v2, s[56:59], s26 offen offset:0 sc1
    s_waitcnt vmcnt(13)
    v_mfma_f32_32x32x16_bf16 v[144:159], a[96:99], a[20:23], v[144:159]
    s_add_u32 s27, s23, 61440
    buffer_load_dwordx4 a[44:47], v2, s[56:59], s27 offen offset:0 sc1
    v_mfma_f32_32x32x16_bf16 v[192:207], a[100:103], a[16:19], v[192:207]
    s_add_u32 s28, s32, 249856
    buffer_load_dwordx4 v[168:171], v2, s[56:59], s28 offen offset:0 sc1
    v_mfma_f32_32x32x16_bf16 v[208:223], a[100:103], a[20:23], v[208:223]
    s_waitcnt vmcnt(13)
    v_mfma_f32_32x32x16_bf16 v[128:143], a[104:107], a[240:243], v[128:143]
    buffer_load_dwordx4 v[172:175], v2, s[56:59], s26 offen offset:1024 sc1
    s_waitcnt vmcnt(13)
    v_mfma_f32_32x32x16_bf16 v[144:159], a[104:107], a[244:247], v[144:159]
    buffer_load_dwordx4 a[48:51], v2, s[56:59], s27 offen offset:1024 sc1
    v_mfma_f32_32x32x16_bf16 v[192:207], a[108:111], a[240:243], v[192:207]
    buffer_load_dwordx4 a[52:55], v2, s[56:59], s28 offen offset:1024 sc1
    v_mfma_f32_32x32x16_bf16 v[208:223], a[108:111], a[244:247], v[208:223]
    s_waitcnt vmcnt(13)
    v_mfma_f32_32x32x16_bf16 v[128:143], a[112:115], a[24:27], v[128:143]
    buffer_load_dwordx4 v[176:179], v2, s[56:59], s26 offen offset:2048 sc1
    s_waitcnt vmcnt(13)
    v_mfma_f32_32x32x16_bf16 v[144:159], a[112:115], a[28:31], v[144:159]
    buffer_load_dwordx4 v[180:183], v2, s[56:59], s27 offen offset:2048 sc1
    v_mfma_f32_32x32x16_bf16 v[192:207], a[116:119], a[24:27], v[192:207]
    buffer_load_dwordx4 a[56:59], v2, s[56:59], s28 offen offset:2048 sc1
    v_mfma_f32_32x32x16_bf16 v[208:223], a[116:119], a[28:31], v[208:223]
    s_waitcnt vmcnt(14)
    v_mfma_f32_32x32x16_bf16 v[128:143], a[120:123], a[248:251], v[128:143]
    v_cmp_ne_u32 vcc, s12, v248
    v_cmp_ne_u32 s[30:31], s13, v249
    s_nop 1
    s_or_b32 s37, vcc_lo, s30
    s_and_b32 s37, s37, s20
    s_cbranch_scc1 L_retry_f3
L_ok_f3:
    s_waitcnt vmcnt(13)
    v_mfma_f32_32x32x16_bf16 v[144:159], a[120:123], a[252:255], v[144:159]
    s_add_u32 s26, s22, 86016
    buffer_load_dwordx4 a[60:63], v2, s[56:59], s26 offen offset:0 sc1
    v_mfma_f32_32x32x16_bf16 v[192:207], a[124:127], a[248:251], v[192:207]
    s_add_u32 s27, s23, 86016
    buffer_load_dwordx4 v[184:187], v2, s[56:59], s27 offen offset:0 sc1
    v_mfma_f32_32x32x16_bf16 v[208:223], a[124:127], a[252:255], v[208:223]
    buffer_load_dwordx4 v[188:191], v2, s[56:59], s28 offen offset:3072 sc1
    s_waitcnt vmcnt(15)
    v_mfma_f32_32x32x16_bf16 v[128:143], a[128:131], a[32:35], v[128:143]
    s_mov_b32 s29, 32768
    buffer_load_dwordx2 v[248:249], v14, s[56:59], s29 offen sc1
    s_waitcnt vmcnt(15)
    v_mfma_f32_32x32x16_bf16 v[144:159], a[128:131], a[36:39], v[144:159]
    buffer_load_dwordx4 a[64:67], v2, s[56:59], s26 offen offset:1024 sc1
    v_mfma_f32_32x32x16_bf16 v[192:207], a[132:135], a[32:35], v[192:207]
    buffer_load_dwordx4 a[68:71], v2, s[56:59], s27 offen offset:1024 sc1
    v_mfma_f32_32x32x16_bf16 v[208:223], a[132:135], a[36:39], v[208:223]
    s_add_u32 s28, s32, 253952
    buffer_load_dwordx4 a[0:3], v2, s[56:59], s28 offen offset:0 sc1
    s_waitcnt vmcnt(17)
    v_mfma_f32_32x32x16_bf16 v[128:143], a[136:139], v[160:163], v[128:143]
    buffer_load_dwordx4 a[4:7], v2, s[56:59], s26 offen offset:2048 sc1
    s_waitcnt vmcnt(17)
    v_mfma_f32_32x32x16_bf16 v[144:159], a[136:139], v[164:167], v[144:159]
    buffer_load_dwordx4 a[72:75], v2, s[56:59], s27 offen offset:2048 sc1
    v_mfma_f32_32x32x16_bf16 v[192:207], a[140:143], v[160:163], v[192:207]
    buffer_load_dwordx4 a[76:79], v2, s[56:59], s28 offen offset:1024 sc1
    v_mfma_f32_32x32x16_bf16 v[208:223], a[140:143], v[164:167], v[208:223]
    s_waitcnt vmcnt(18)
    v_mfma_f32_32x32x16_bf16 v[128:143], a[144:147], a[40:43], v[128:143]
    buffer_load_dwordx4 a[224:227], v2, s[56:59], s26 offen offset:3072 sc1
    s_waitcnt vmcnt(18)
    v_mfma_f32_32x32x16_bf16 v[144:159], a[144:147], a[44:47], v[144:159]
    buffer_load_dwordx4 a[228:231], v2, s[56:59], s27 offen offset:3072 sc1
    v_mfma_f32_32x32x16_bf16 v[192:207], a[148:151], a[40:43], v[192:207]
    buffer_load_dwordx4 a[80:83], v2, s[56:59], s28 offen offset:2048 sc1
    v_mfma_f32_32x32x16_bf16 v[208:223], a[148:151], a[44:47], v[208:223]
    s_waitcnt vmcnt(18)
    v_mfma_f32_32x32x16_bf16 v[128:143], a[152:155], v[172:175], v[128:143]
    s_add_u32 s26, s22, 90112
    buffer_load_dwordx4 a[84:87], v2, s[56:59], s26 offen offset:0 sc1
    s_waitcnt vmcnt(18)
    v_mfma_f32_32x32x16_bf16 v[144:159], a[152:155], a[48:51], v[144:159]
    s_add_u32 s27, s23, 90112
    buffer_load_dwordx4 a[8:11], v2, s[56:59], s27 offen offset:0 sc1
    v_mfma_f32_32x32x16_bf16 v[192:207], a[156:159], v[172:175], v[192:207]
    buffer_load_dwordx4 a[12:15], v2, s[56:59], s28 offen offset:3072 sc1
    v_mfma_f32_32x32x16_bf16 v[208:223], a[156:159], a[48:51], v[208:223]
    s_waitcnt vmcnt(18)
    v_mfma_f32_32x32x16_bf16 v[128:143], a[160:163], v[176:179], v[128:143]
    buffer_load_dwordx4 a[88:91], v2, s[56:59], s26 offen offset:1024 sc1
    s_waitcnt vmcnt(18)
    v_mfma_f32_32x32x16_bf16 v[144:159], a[160:163], v[180:183], v[144:159]
    v_mfma_f32_32x32x16_bf16 v[192:207], a[164:167], v[176:179], v[192:207]
    buffer_load_dwordx4 a[92:95], v2, s[56:59], s27 offen offset:1024 sc1
    v_mfma_f32_32x32x16_bf16 v[208:223], a[164:167], v[180:183], v[208:223]
    s_waitcnt vmcnt(17)
    v_mfma_f32_32x32x16_bf16 v[128:143], a[168:171], a[60:63], v[128:143]
    buffer_load_dwordx4 a[232:235], v2, s[56:59], s26 offen offset:2048 sc1
    s_waitcnt vmcnt(17)
    v_mfma_f32_32x32x16_bf16 v[144:159], a[168:171], v[184:187], v[144:159]
    v_mfma_f32_32x32x16_bf16 v[192:207], a[172:175], a[60:63], v[192:207]
    buffer_load_dwordx4 a[236:239], v2, s[56:59], s27 offen offset:2048 sc1
    v_mfma_f32_32x32x16_bf16 v[208:223], a[172:175], v[184:187], v[208:223]
    s_waitcnt vmcnt(15)
    v_mfma_f32_32x32x16_bf16 v[128:143], a[176:179], a[64:67], v[128:143]
    v_cmp_ne_u32 vcc, s12, v248
    v_cmp_ne_u32 s[30:31], s13, v249
    s_nop 1
    s_or_b32 s37, vcc_lo, s30
    s_and_b32 s37, s37, s20
    s_cbranch_scc1 L_retry_f4
L_ok_f4:
    s_waitcnt vmcnt(14)
    v_mfma_f32_32x32x16_bf16 v[144:159], a[176:179], a[68:71], v[144:159]
    s_add_u32 s26, s33, 114688
    buffer_load_dwordx4 a[96:99], v2, s[56:59], s26 offen offset:0 sc1
    v_mfma_f32_32x32x16_bf16 v[192:207], a[180:183], a[64:67], v[192:207]
    s_add_u32 s27, s34, 114688
    buffer_load_dwordx4 a[100:103], v2, s[56:59], s27 offen offset:0 sc1
    v_mfma_f32_32x32x16_bf16 v[208:223], a[180:183], a[68:71], v[208:223]
    s_waitcnt vmcnt(14)
    v_mfma_f32_32x32x16_bf16 v[128:143], a[184:187], a[4:7], v[128:143]
    buffer_load_dwordx4 a[16:19], v2, s[56:59], s26 offen offset:1024 sc1
    s_waitcnt vmcnt(14)
    v_mfma_f32_32x32x16_bf16 v[144:159], a[184:187], a[72:75], v[144:159]
    v_mfma_f32_32x32x16_bf16 v[192:207], a[188:191], a[4:7], v[192:207]
    buffer_load_dwordx4 a[20:23], v2, s[56:59], s27 offen offset:1024 sc1
    v_mfma_f32_32x32x16_bf16 v[208:223], a[188:191], a[72:75], v[208:223]
    s_waitcnt vmcnt(13)
    v_mfma_f32_32x32x16_bf16 v[128:143], a[192:195], a[224:227], v[128:143]
    buffer_load_dwordx4 a[104:107], v2, s[56:59], s26 offen offset:2048 sc1
    s_waitcnt vmcnt(13)
    v_mfma_f32_32x32x16_bf16 v[144:159], a[192:195], a[228:231], v[144:159]
    v_mfma_f32_32x32x16_bf16 v[192:207], a[196:199], a[224:227], v[192:207]
    buffer_load_dwordx4 a[108:111], v2, s[56:59], s27 offen offset:2048 sc1
    v_mfma_f32_32x32x16_bf16 v[208:223], a[196:199], a[228:231], v[208:223]
    s_waitcnt vmcnt(12)
    v_mfma_f32_32x32x16_bf16 v[128:143], a[200:203], a[84:87], v[128:143]
    buffer_load_dwordx4 a[240:243], v2, s[56:59], s26 offen offset:3072 sc1
    s_waitcnt vmcnt(12)
    v_mfma_f32_32x32x16_bf16 v[144:159], a[200:203], a[8:11], v[144:159]
    v_mfma_f32_32x32x16_bf16 v[192:207], a[204:207], a[84:87], v[192:207]
    buffer_load_dwordx4 a[244:247], v2, s[56:59], s27 offen offset:3072 sc1
    v_mfma_f32_32x32x16_bf16 v[208:223], a[204:207], a[8:11], v[208:223]
    s_waitcnt vmcnt(11)
    v_mfma_f32_32x32x16_bf16 v[128:143], a[208:211], a[88:91], v[128:143]
    s_add_u32 s26, s33, 118784
    buffer_load_dwordx4 a[112:115], v2, s[56:59], s26 offen offset:0 sc1
    s_waitcnt vmcnt(11)
    v_mfma_f32_32x32x16_bf16 v[144:159], a[208:211], a[92:95], v[144:159]
    v_mfma_f32_32x32x16_bf16 v[192:207], a[212:215], a[88:91], v[192:207]
    s_add_u32 s27, s34, 118784
    buffer_load_dwordx4 a[116:119], v2, s[56:59], s27 offen offset:0 sc1
    v_mfma_f32_32x32x16_bf16 v[208:223], a[212:215], a[92:95], v[208:223]
    s_waitcnt vmcnt(11)
    v_mfma_f32_32x32x16_bf16 v[128:143], a[216:219], a[232:235], v[128:143]
    buffer_load_dwordx4 a[24:27], v2, s[56:59], s26 offen offset:1024 sc1
    s_waitcnt vmcnt(11)
    v_mfma_f32_32x32x16_bf16 v[144:159], a[216:219], a[236:239], v[144:159]
    v_mfma_f32_32x32x16_bf16 v[192:207], a[220:223], a[232:235], v[192:207]
    buffer_load_dwordx4 a[28:31], v2, s[56:59], s27 offen offset:1024 sc1
    v_mfma_f32_32x32x16_bf16 v[208:223], a[220:223], a[236:239], v[208:223]
    s_waitcnt vmcnt(11)
    v_mfma_f32_32x32x16_bf16 v[128:143], v[48:51], a[96:99], v[128:143]
    buffer_load_dwordx4 a[120:123], v2, s[56:59], s26 offen offset:2048 sc1
    s_waitcnt vmcnt(11)
    v_mfma_f32_32x32x16_bf16 v[144:159], v[48:51], a[100:103], v[144:159]
    v_mfma_f32_32x32x16_bf16 v[192:207], v[52:55], a[96:99], v[192:207]
    buffer_load_dwordx4 a[124:127], v2, s[56:59], s27 offen offset:2048 sc1
    v_mfma_f32_32x32x16_bf16 v[208:223], v[52:55], a[100:103], v[208:223]
    s_waitcnt vmcnt(11)
    v_mfma_f32_32x32x16_bf16 v[128:143], v[56:59], a[16:19], v[128:143]
    buffer_load_dwordx4 a[248:251], v2, s[56:59], s26 offen offset:3072 sc1
    s_waitcnt vmcnt(11)
    v_mfma_f32_32x32x16_bf16 v[144:159], v[56:59], a[20:23], v[144:159]
    v_mfma_f32_32x32x16_bf16 v[192:207], v[60:63], a[16:19], v[192:207]
    buffer_load_dwordx4 a[252:255], v2, s[56:59], s27 offen offset:3072 sc1
    v_mfma_f32_32x32x16_bf16 v[208:223], v[60:63], a[20:23], v[208:223]
    s_waitcnt vmcnt(11)
    v_mfma_f32_32x32x16_bf16 v[128:143], v[64:67], a[104:107], v[128:143]
    s_add_u32 s26, s33, 122880
    buffer_load_dwordx4 a[128:131], v2, s[56:59], s26 offen offset:0 sc1
    s_waitcnt vmcnt(11)
    v_mfma_f32_32x32x16_bf16 v[144:159], v[64:67], a[108:111], v[144:159]
    v_mfma_f32_32x32x16_bf16 v[192:207], v[68:71], a[104:107], v[192:207]
    s_add_u32 s27, s34, 122880
    buffer_load_dwordx4 a[132:135], v2, s[56:59], s27 offen offset:0 sc1
    v_mfma_f32_32x32x16_bf16 v[208:223], v[68:71], a[108:111], v[208:223]
    s_waitcnt vmcnt(11)
    v_mfma_f32_32x32x16_bf16 v[128:143], v[72:75], a[240:243], v[128:143]
    buffer_load_dwordx4 a[32:35], v2, s[56:59], s26 offen offset:1024 sc1
    s_waitcnt vmcnt(11)
    v_mfma_f32_32x32x16_bf16 v[144:159], v[72:75], a[244:247], v[144:159]
    v_mfma_f32_32x32x16_bf16 v[192:207], v[76:79], a[240:243], v[192:207]
    buffer_load_dwordx4 a[36:39], v2, s[56:59], s27 offen offset:1024 sc1
    v_mfma_f32_32x32x16_bf16 v[208:223], v[76:79], a[244:247], v[208:223]
    s_waitcnt vmcnt(11)
    v_mfma_f32_32x32x16_bf16 v[128:143], v[80:83], a[112:115], v[128:143]
    buffer_load_dwordx4 a[136:139], v2, s[56:59], s26 offen offset:2048 sc1
    s_waitcnt vmcnt(11)
    v_mfma_f32_32x32x16_bf16 v[144:159], v[80:83], a[116:119], v[144:159]
    v_mfma_f32_32x32x16_bf16 v[192:207], v[84:87], a[112:115], v[192:207]
    buffer_load_dwordx4 a[140:143], v2, s[56:59], s27 offen offset:2048 sc1
    v_mfma_f32_32x32x16_bf16 v[208:223], v[84:87], a[116:119], v[208:223]
    s_waitcnt vmcnt(11)
    v_mfma_f32_32x32x16_bf16 v[128:143], v[88:91], a[24:27], v[128:143]
    buffer_load_dwordx4 v[160:163], v2, s[56:59], s26 offen offset:3072 sc1
    s_waitcnt vmcnt(11)
    v_mfma_f32_32x32x16_bf16 v[144:159], v[88:91], a[28:31], v[144:159]
    v_mfma_f32_32x32x16_bf16 v[192:207], v[92:95], a[24:27], v[192:207]
    buffer_load_dwordx4 v[164:167], v2, s[56:59], s27 offen offset:3072 sc1
    v_mfma_f32_32x32x16_bf16 v[208:223], v[92:95], a[28:31], v[208:223]
    s_waitcnt vmcnt(11)
    v_mfma_f32_32x32x16_bf16 v[128:143], v[96:99], a[120:123], v[128:143]
    s_add_u32 s26, s33, 126976
    buffer_load_dwordx4 a[144:147], v2, s[56:59], s26 offen offset:0 sc1
    s_waitcnt vmcnt(11)
    v_mfma_f32_32x32x16_bf16 v[144:159], v[96:99], a[124:127], v[144:159]
    v_mfma_f32_32x32x16_bf16 v[192:207], v[100:103], a[120:123], v[192:207]
    s_add_u32 s27, s34, 126976
    buffer_load_dwordx4 a[148:151], v2, s[56:59], s27 offen offset:0 sc1
    v_mfma_f32_32x32x16_bf16 v[208:223], v[100:103], a[124:127], v[208:223]
    s_waitcnt vmcnt(11)
    v_mfma_f32_32x32x16_bf16 v[128:143], v[104:107], a[248:251], v[128:143]
    buffer_load_dwordx4 a[40:43], v2, s[56:59], s26 offen offset:1024 sc1
    s_waitcnt vmcnt(11)
    v_mfma_f32_32x32x16_bf16 v[144:159], v[104:107], a[252:255], v[144:159]
    v_mfma_f32_32x32x16_bf16 v[192:207], v[108:111], a[248:251], v[192:207]
    buffer_load_dwordx4 a[44:47], v2, s[56:59], s27 offen offset:1024 sc1
    v_mfma_f32_32x32x16_bf16 v[208:223], v[108:111], a[252:255], v[208:223]
    s_waitcnt vmcnt(11)
    v_mfma_f32_32x32x16_bf16 v[128:143], v[112:115], a[128:131], v[128:143]
    s_barrier
    s_waitcnt vmcnt(10)
    v_mfma_f32_32x32x16_bf16 v[144:159], v[112:115], a[132:135], v[144:159]
    v_mfma_f32_32x32x16_bf16 v[192:207], v[116:119], a[128:131], v[192:207]
    v_mfma_f32_32x32x16_bf16 v[208:223], v[116:119], a[132:135], v[208:223]
    s_waitcnt vmcnt(9)
    v_mfma_f32_32x32x16_bf16 v[128:143], v[120:123], a[32:35], v[128:143]
    s_waitcnt vmcnt(8)
    v_mfma_f32_32x32x16_bf16 v[144:159], v[120:123], a[36:39], v[144:159]
    v_mfma_f32_32x32x16_bf16 v[192:207], v[124:127], a[32:35], v[192:207]
    v_mfma_f32_32x32x16_bf16 v[208:223], v[124:127], a[36:39], v[208:223]
    s_waitcnt vmcnt(7)
    v_mfma_f32_32x32x16_bf16 v[128:143], v[168:171], a[136:139], v[128:143]
    s_waitcnt vmcnt(6)
    v_mfma_f32_32x32x16_bf16 v[144:159], v[168:171], a[140:143], v[144:159]
    v_mfma_f32_32x32x16_bf16 v[192:207], a[52:55], a[136:139], v[192:207]
    v_mfma_f32_32x32x16_bf16 v[208:223], a[52:55], a[140:143], v[208:223]
    s_waitcnt vmcnt(5)
    v_mfma_f32_32x32x16_bf16 v[128:143], a[56:59], v[160:163], v[128:143]
    s_waitcnt vmcnt(4)
    v_mfma_f32_32x32x16_bf16 v[144:159], a[56:59], v[164:167], v[144:159]
    s_waitcnt vmcnt(3)
    v_mfma_f32_32x32x16_bf16 v[128:143], a[0:3], a[144:147], v[128:143]
    s_waitcnt vmcnt(2)
    v_mfma_f32_32x32x16_bf16 v[144:159], a[0:3], a[148:151], v[144:159]
    s_waitcnt vmcnt(1)
    v_mfma_f32_32x32x16_bf16 v[128:143], a[80:83], a[40:43], v[128:143]
    s_waitcnt vmcnt(0)
    v_mfma_f32_32x32x16_bf16 v[144:159], a[80:83], a[44:47], v[144:159]
    v_mfma_f32_32x32x16_bf16 v[192:207], v[188:191], v[160:163], v[192:207]
    v_mfma_f32_32x32x16_bf16 v[208:223], v[188:191], v[164:167], v[208:223]
    s_nop 7
    ds_write_b128 v40, v[128:131] offset:0
    ds_write_b128 v41, v[132:135] offset:0
    v_mfma_f32_32x32x16_bf16 v[192:207], a[76:79], a[144:147], v[192:207]
    ds_write_b128 v42, v[136:139] offset:0
    ds_write_b128 v43, v[140:143] offset:0
    v_mfma_f32_32x32x16_bf16 v[208:223], a[76:79], a[148:151], v[208:223]
    ds_write_b128 v40, v[144:147] offset:8192
    ds_write_b128 v41, v[148:151] offset:8192
    v_mfma_f32_32x32x16_bf16 v[192:207], a[12:15], a[40:43], v[192:207]
    ds_write_b128 v42, v[152:155] offset:8192
    ds_write_b128 v43, v[156:159] offset:8192
    v_mfma_f32_32x32x16_bf16 v[208:223], a[12:15], a[44:47], v[208:223]
    s_nop 8
    ds_write_b128 v40, v[192:195] offset:128
    ds_write_b128 v41, v[196:199] offset:128
    ds_write_b128 v42, v[200:203] offset:128
    ds_write_b128 v43, v[204:207] offset:128
    ds_write_b128 v40, v[208:211] offset:8320
    ds_write_b128 v41, v[212:215] offset:8320
    ds_write_b128 v42, v[216:219] offset:8320
    ds_write_b128 v43, v[220:223] offset:8320
    s_waitcnt lgkmcnt(0)
    s_barrier
    ds_read_b128 v[48:51], v44 offset:0
    ds_read_b128 v[52:55], v44 offset:24576
    ds_read_b128 v[56:59], v44 offset:49152
    ds_read_b128 v[60:63], v38 offset:0
    ds_read_b128 v[64:67], v45 offset:0
    ds_read_b128 v[68:71], v45 offset:24576
    ds_read_b128 v[72:75], v45 offset:49152
    ds_read_b128 v[76:79], v39 offset:0
    ds_read_b128 v[80:83], v44 offset:2048
    ds_read_b128 v[84:87], v44 offset:26624
    ds_read_b128 v[88:91], v44 offset:51200
    ds_read_b128 v[92:95], v38 offset:2048
    ds_read_b128 v[96:99], v45 offset:2048
    ds_read_b128 v[100:103], v45 offset:26624
    ds_read_b128 v[104:107], v45 offset:51200
    ds_read_b128 v[108:111], v39 offset:2048
    s_waitcnt lgkmcnt(14)
    v_pk_add_f32 v[48:49], v[48:49], v[52:53]
    v_pk_add_f32 v[50:51], v[50:51], v[54:55]
    s_waitcnt lgkmcnt(12)
    v_pk_add_f32 v[56:57], v[56:57], v[60:61]
    v_pk_add_f32 v[58:59], v[58:59], v[62:63]
    v_pk_add_f32 v[16:17], v[16:17], v[48:49]
    v_pk_add_f32 v[18:19], v[18:19], v[50:51]
    v_pk_add_f32 v[16:17], v[16:17], v[56:57]
    v_pk_add_f32 v[18:19], v[18:19], v[58:59]
    s_add_u32 s101, s39, 0
    buffer_store_dwordx4 v[16:19], v46, s[60:63], s101 offen sc1
    s_waitcnt lgkmcnt(10)
    v_pk_add_f32 v[64:65], v[64:65], v[68:69]
    v_pk_add_f32 v[66:67], v[66:67], v[70:71]
    s_waitcnt lgkmcnt(8)
    v_pk_add_f32 v[72:73], v[72:73], v[76:77]
    v_pk_add_f32 v[74:75], v[74:75], v[78:79]
    v_pk_add_f32 v[20:21], v[20:21], v[64:65]
    v_pk_add_f32 v[22:23], v[22:23], v[66:67]
    v_pk_add_f32 v[20:21], v[20:21], v[72:73]
    v_pk_add_f32 v[22:23], v[22:23], v[74:75]
    s_add_u32 s101, s39, 7168
    buffer_store_dwordx4 v[20:23], v46, s[60:63], s101 offen sc1
    s_waitcnt lgkmcnt(6)
    v_pk_add_f32 v[80:81], v[80:81], v[84:85]
    v_pk_add_f32 v[82:83], v[82:83], v[86:87]
    s_waitcnt lgkmcnt(4)
    v_pk_add_f32 v[88:89], v[88:89], v[92:93]
    v_pk_add_f32 v[90:91], v[90:91], v[94:95]
    v_pk_add_f32 v[24:25], v[24:25], v[80:81]
    v_pk_add_f32 v[26:27], v[26:27], v[82:83]
    v_pk_add_f32 v[24:25], v[24:25], v[88:89]
    v_pk_add_f32 v[26:27], v[26:27], v[90:91]
    s_add_u32 s101, s39, 14336
    buffer_store_dwordx4 v[24:27], v46, s[60:63], s101 offen sc1
    s_waitcnt lgkmcnt(2)
    v_pk_add_f32 v[96:97], v[96:97], v[100:101]
    v_pk_add_f32 v[98:99], v[98:99], v[102:103]
    s_waitcnt lgkmcnt(0)
    v_pk_add_f32 v[104:105], v[104:105], v[108:109]
    v_pk_add_f32 v[106:107], v[106:107], v[110:111]
    v_pk_add_f32 v[28:29], v[28:29], v[96:97]
    v_pk_add_f32 v[30:31], v[30:31], v[98:99]
    v_pk_add_f32 v[28:29], v[28:29], v[104:105]
    v_pk_add_f32 v[30:31], v[30:31], v[106:107]
    s_add_u32 s101, s39, 21504
    buffer_store_dwordx4 v[28:31], v46, s[60:63], s101 offen sc1
    s_cmp_eq_u32 s8, 15
    s_cbranch_scc0 L_exit
    s_cmp_eq_u32 s9, 13
    s_cbranch_scc0 L_exit
    s_cmp_eq_u32 s10, 3
    s_cbranch_scc0 L_exit
    s_mov_b32 s98, 0
    s_add_u32 s37, s98, 0
    s_mov_b64 exec, 1
    buffer_store_dwordx2 v[254:255], v11, s[56:59], s37 offen sc1
    s_mov_b64 exec, -1
    s_endpgm
L_retry_p0:
    s_mov_b32 s24, 0
L_loop_p0:
    s_sleep 1
    buffer_load_dwordx2 v[250:251], v252, s[56:59], 0 offen offset:0 sc1
    s_waitcnt vmcnt(0)
    v_cmp_ne_u32 vcc, s12, v250
    v_cmp_ne_u32 s[30:31], s13, v251
    s_add_u32 s24, s24, 1
    s_cmp_gt_u32 s24, 65536
    s_cbranch_scc1 L_ok_p0
    s_or_b32 s37, vcc_lo, s30
    s_and_b32 s37, s37, s69
    s_cbranch_scc1 L_loop_p0
    s_branch L_ok_p0
L_retry_p3:
    s_mov_b32 s24, 0
L_loop_p3:
    s_sleep 1
    buffer_load_dwordx2 v[250:251], v252, s[56:59], 0 offen offset:3072 sc1
    s_waitcnt vmcnt(0)
    v_cmp_ne_u32 vcc, s12, v250
    v_cmp_ne_u32 s[30:31], s13, v251
    s_add_u32 s24, s24, 1
    s_cmp_gt_u32 s24, 65536
    s_cbranch_scc1 L_ok_p3
    s_or_b32 s37, vcc_lo, s30
    s_and_b32 s37, s37, s69
    s_cbranch_scc1 L_loop_p3
    s_branch L_ok_p3
L_retry_p4:
    s_mov_b32 s24, 0
L_loop_p4:
    s_sleep 1
    buffer_load_dwordx2 v[250:251], v252, s[56:59], s68 offen sc1
    s_waitcnt vmcnt(0)
    v_cmp_ne_u32 vcc, s12, v250
    v_cmp_ne_u32 s[30:31], s13, v251
    s_add_u32 s24, s24, 1
    s_cmp_gt_u32 s24, 65536
    s_cbranch_scc1 L_ok_p4
    s_or_b32 s37, vcc_lo, s30
    s_and_b32 s37, s37, 0x7f7f
    s_cbranch_scc1 L_loop_p4
    s_branch L_ok_p4
L_retry_lb:
    s_mov_b32 s24, 0
L_loop_lb:
    s_sleep 1
    buffer_load_dwordx4 v[16:19], v199, s[44:47], 0 offen sc1
    v_subrev_u32 v200, 1024, v199
    buffer_load_dwordx4 v[20:23], v200, s[44:47], 0 offen sc1
    v_subrev_u32 v200, 2048, v199
    buffer_load_dwordx4 v[24:27], v200, s[44:47], 0 offen sc1
    v_subrev_u32 v200, 3072, v199
    buffer_load_dwordx4 v[28:31], v200, s[44:47], 0 offen sc1
    v_subrev_u32 v200, 4096, v199
    buffer_load_dwordx4 v[32:35], v200, s[44:47], 0 offen sc1
    v_subrev_u32 v200, 5120, v199
    buffer_load_dwordx4 v[36:39], v200, s[44:47], 0 offen sc1
    v_subrev_u32 v200, 6144, v199
    buffer_load_dwordx4 v[40:43], v200, s[44:47], 0 offen sc1
    v_subrev_u32 v200, 7168, v199
    buffer_load_dwordx4 v[44:47], v200, s[44:47], 0 offen sc1
    s_waitcnt vmcnt(0)
    s_add_u32 s24, s24, 1
    s_cmp_gt_u32 s24, 65536
    s_cbranch_scc1 L_ok_lb
    v_add3_u32 v3, v18, v22, v26
    v_add3_u32 v4, v19, v23, v27
    v_add3_u32 v3, v3, v30, v34
    v_add3_u32 v4, v4, v31, v35
    v_add3_u32 v3, v3, v38, v42
    v_add3_u32 v4, v4, v39, v43
    v_add_u32 v3, v3, v46
    v_add_u32 v4, v4, v47
    v_cmp_ne_u32 vcc, v3, v5
    v_cmp_ne_u32 s[30:31], v4, v6
    s_nop 1
    s_or_b64 vcc, vcc, s[30:31]
    s_cbranch_scc1 L_loop_lb
    s_branch L_ok_lb
L_retry_f0:
    s_mov_b32 s24, 0
L_loop_f0:
    s_sleep 1
    buffer_load_dwordx2 v[248:249], v14, s[56:59], s29 offen sc1
    s_waitcnt vmcnt(0)
    v_cmp_ne_u32 vcc, s12, v248
    v_cmp_ne_u32 s[30:31], s13, v249
    s_add_u32 s24, s24, 1
    s_cmp_gt_u32 s24, 65536
    s_cbranch_scc1 L_ok_f0
    s_or_b32 s37, vcc_lo, s30
    s_and_b32 s37, s37, s20
    s_cbranch_scc1 L_loop_f0
    s_branch L_ok_f0
L_retry_f1:
    s_mov_b32 s24, 0
L_loop_f1:
    s_sleep 1
    buffer_load_dwordx2 v[248:249], v14, s[56:59], s29 offen sc1
    s_waitcnt vmcnt(0)
    v_cmp_ne_u32 vcc, s12, v248
    v_cmp_ne_u32 s[30:31], s13, v249
    s_add_u32 s24, s24, 1
    s_cmp_gt_u32 s24, 65536
    s_cbranch_scc1 L_ok_f1
    s_or_b32 s37, vcc_lo, s30
    s_and_b32 s37, s37, s20
    s_cbranch_scc1 L_loop_f1
    s_branch L_ok_f1
L_retry_f2:
    s_mov_b32 s24, 0
L_loop_f2:
    s_sleep 1
    buffer_load_dwordx2 v[248:249], v14, s[56:59], s29 offen sc1
    s_waitcnt vmcnt(0)
    v_cmp_ne_u32 vcc, s12, v248
    v_cmp_ne_u32 s[30:31], s13, v249
    s_add_u32 s24, s24, 1
    s_cmp_gt_u32 s24, 65536
    s_cbranch_scc1 L_ok_f2
    s_or_b32 s37, vcc_lo, s30
    s_and_b32 s37, s37, s20
    s_cbranch_scc1 L_loop_f2
    s_branch L_ok_f2
L_retry_f3:
    s_mov_b32 s24, 0
L_loop_f3:
    s_sleep 1
    buffer_load_dwordx2 v[248:249], v14, s[56:59], s29 offen sc1
    s_waitcnt vmcnt(0)
    v_cmp_ne_u32 vcc, s12, v248
    v_cmp_ne_u32 s[30:31], s13, v249
    s_add_u32 s24, s24, 1
    s_cmp_gt_u32 s24, 65536
    s_cbranch_scc1 L_ok_f3
    s_or_b32 s37, vcc_lo, s30
    s_and_b32 s37, s37, s20
    s_cbranch_scc1 L_loop_f3
    s_branch L_ok_f3
L_retry_f4:
    s_mov_b32 s24, 0
L_loop_f4:
    s_sleep 1
    buffer_load_dwordx2 v[248:249], v14, s[56:59], s29 offen sc1
    s_waitcnt vmcnt(0)
    v_cmp_ne_u32 vcc, s12, v248
    v_cmp_ne_u32 s[30:31], s13, v249
    s_add_u32 s24, s24, 1
    s_cmp_gt_u32 s24, 65536
    s_cbranch_scc1 L_ok_f4
    s_or_b32 s37, vcc_lo, s30
    s_and_b32 s37, s37, s20
    s_cbranch_scc1 L_loop_f4
    s_branch L_ok_f4
L_prep:
    s_lshl_b32 s8, s98, 2
    s_add_u32 s8, s8, s99
    s_sub_u32 s8, s8, 28
    s_cmp_ge_u32 s8, 28
    s_cbranch_scc1 L_exit
    s_lshr_b32 s85, s8, 1
    s_lshl_b32 s85, s85, 7
    s_and_b32 s98, s8, 1
    s_lshl_b32 s98, s98, 4
    s_add_u32 s85, s85, s98
    s_mul_i32 s85, s85, 896
    s_lshl_b32 s87, s10, 2
    s_min_u32 s87, s87, 10
    s_lshl_b32 s98, s87, 6
    s_add_u32 s85, s85, s98
    s_mul_i32 s100, s10, 26624
    v_lshrrev_b32 v21, 4, v1
    v_mul_u32_u24 v21, 896, v21
    v_and_b32 v5, 15, v1
    v_lshl_add_u32 v21, v5, 4, v21
    s_lshl_b32 s84, s8, 2
    s_add_u32 s84, s84, s10
    s_mul_i32 s88, s84, 4682
    s_lshr_b32 s88, s88, 16
    s_mul_i32 s98, s88, 14
    s_sub_u32 s89, s84, s98
    s_waitcnt lgkmcnt(0)
    s_mov_b32 s44, s38
    s_mov_b32 s45, s39
    s_mov_b32 s46, 1605632
    s_mov_b32 s47, 0x20000
    s_add_u32 m0, s100, 0
    s_add_u32 s98, s85, 0
    buffer_load_dwordx4 v21, s[44:47], s98 offen lds
    s_add_u32 m0, s100, 1024
    s_add_u32 s98, s85, 3584
    buffer_load_dwordx4 v21, s[44:47], s98 offen lds
    s_add_u32 m0, s100, 2048
    s_add_u32 s98, s85, 7168
    buffer_load_dwordx4 v21, s[44:47], s98 offen lds
    s_add_u32 m0, s100, 3072
    s_add_u32 s98, s85, 10752
    buffer_load_dwordx4 v21, s[44:47], s98 offen lds
    s_mov_b32 s56, s6
    s_mov_b32 s57, s7
    s_mov_b32 s58, 15204352
    s_mov_b32 s59, 0x20000
    buffer_load_dwordx2 v[252:253], v11, s[56:59], 0 offen sc1
    s_add_u32 m0, s100, 4096
    s_add_u32 s98, s85, 28672
    buffer_load_dwordx4 v21, s[44:47], s98 offen lds
    s_add_u32 m0, s100, 5120
    s_add_u32 s98, s85, 32256
    buffer_load_dwordx4 v21, s[44:47], s98 offen lds
    s_add_u32 m0, s100, 6144
    s_add_u32 s98, s85, 35840
    buffer_load_dwordx4 v21, s[44:47], s98 offen lds
    s_add_u32 m0, s100, 7168
    s_add_u32 s98, s85, 39424
    buffer_load_dwordx4 v21, s[44:47], s98 offen lds
    s_mov_b32 s64, s18
    s_mov_b32 s65, s19
    s_mov_b32 s66, 896
    s_mov_b32 s67, 0x20000
    s_mov_b32 s68, s20
    s_mov_b32 s69, s21
    s_mov_b32 s70, 896
    s_mov_b32 s71, 0x20000
    s_mov_b32 s72, s30
    s_mov_b32 s73, s31
    s_mov_b32 s74, 896
    s_mov_b32 s75, 0x20000
    v_lshlrev_b32 v5, 1, v1
    s_lshl_b32 s99, s88, 7
    buffer_load_ushort v224, v5, s[64:67], s99 offen
    buffer_load_ushort v225, v5, s[68:71], s99 offen
    buffer_load_ushort v226, v5, s[72:75], s99 offen
    s_add_u32 m0, s100, 8192
    s_add_u32 s98, s85, 57344
    buffer_load_dwordx4 v21, s[44:47], s98 offen lds
    s_add_u32 m0, s100, 9216
    s_add_u32 s98, s85, 60928
    buffer_load_dwordx4 v21, s[44:47], s98 offen lds
    s_add_u32 m0, s100, 10240
    s_add_u32 s98, s85, 64512
    buffer_load_dwordx4 v21, s[44:47], s98 offen lds
    s_add_u32 m0, s100, 11264
    s_add_u32 s98, s85, 68096
    buffer_load_dwordx4 v21, s[44:47], s98 offen lds
    s_mov_b32 s48, s26
    s_mov_b32 s49, s27
    s_mov_b32 s50, 401408
    s_mov_b32 s51, 0x20000
    s_mov_b32 s52, s28
    s_mov_b32 s53, s29
    s_mov_b32 s54, 401408
    s_mov_b32 s55, 0x20000
    v_lshrrev_b32 v16, 2, v1
    v_and_b32 v16, 3, v16
    v_lshl_add_u32 v16, v12, 2, v16
    v_lshlrev_b32 v16, 8, v16
    v_and_b32 v5, 16, v1
    v_lshl_add_u32 v16, v5, 1, v16
    v_and_b32 v5, 3, v1
    v_lshl_add_u32 v16, v5, 3, v16
    v_add_u32 v16, s100, v16
    v_lshrrev_b32 v5, 1, v13
    v_and_b32 v5, 7, v5
    v_xor_b32 v5, v5, v12
    v_lshlrev_b32 v5, 4, v5
    v_lshl_add_u32 v5, v13, 7, v5
    v_add_u32 v17, s100, v5
    v_xor_b32 v18, 32, v17
    v_xor_b32 v19, 64, v17
    v_xor_b32 v20, 96, v17
    s_lshr_b32 s86, s87, 1
    s_mul_i32 s86, s86, 168
    s_add_u32 s86, s86, s8
    s_lshl_b32 s86, s86, 11
    s_add_u32 s86, s86, 1048576
    s_lshl_b32 s92, s10, 5
    s_add_u32 s92, s92, s8
    s_lshl_b32 s92, s92, 3
    s_mul_i32 s101, s89, 28672
    s_add_u32 s101, s101, s99
    s_waitcnt vmcnt(12)
    ds_read_b64_tr_b16 v[64:65], v16 offset:0
    ds_read_b64_tr_b16 v[66:67], v16 offset:2048
    ds_read_b64_tr_b16 v[68:69], v16 offset:64
    ds_read_b64_tr_b16 v[70:71], v16 offset:2112
    ds_read_b64_tr_b16 v[72:73], v16 offset:128
    ds_read_b64_tr_b16 v[74:75], v16 offset:2176
    ds_read_b64_tr_b16 v[76:77], v16 offset:192
    ds_read_b64_tr_b16 v[78:79], v16 offset:2240
    s_add_u32 s98, s86, 0
    s_waitcnt lgkmcnt(6)
    buffer_store_dwordx4 v[64:67], v2, s[56:59], s98 offen offset:0 sc1
    s_waitcnt lgkmcnt(4)
    buffer_store_dwordx4 v[68:71], v2, s[56:59], s98 offen offset:1024 sc1
    s_add_u32 s98, s86, 344064
    s_waitcnt lgkmcnt(2)
    buffer_store_dwordx4 v[72:75], v2, s[56:59], s98 offen offset:0 sc1
    s_waitcnt lgkmcnt(0)
    buffer_store_dwordx4 v[76:79], v2, s[56:59], s98 offen offset:1024 sc1
    s_waitcnt vmcnt(11)
    ds_read_b64_tr_b16 v[80:81], v16 offset:4096
    ds_read_b64_tr_b16 v[82:83], v16 offset:6144
    ds_read_b64_tr_b16 v[84:85], v16 offset:4160
    ds_read_b64_tr_b16 v[86:87], v16 offset:6208
    ds_read_b64_tr_b16 v[88:89], v16 offset:4224
    ds_read_b64_tr_b16 v[90:91], v16 offset:6272
    ds_read_b64_tr_b16 v[92:93], v16 offset:4288
    ds_read_b64_tr_b16 v[94:95], v16 offset:6336
    s_add_u32 s98, s86, 57344
    s_waitcnt lgkmcnt(6)
    buffer_store_dwordx4 v[80:83], v2, s[56:59], s98 offen offset:0 sc1
    s_waitcnt lgkmcnt(4)
    buffer_store_dwordx4 v[84:87], v2, s[56:59], s98 offen offset:1024 sc1
    s_add_u32 s98, s86, 401408
    s_waitcnt lgkmcnt(2)
    buffer_store_dwordx4 v[88:91], v2, s[56:59], s98 offen offset:0 sc1
    s_waitcnt lgkmcnt(0)
    buffer_store_dwordx4 v[92:95], v2, s[56:59], s98 offen offset:1024 sc1
    s_waitcnt vmcnt(8)
    ds_read_b64_tr_b16 v[96:97], v16 offset:8192
    ds_read_b64_tr_b16 v[98:99], v16 offset:10240
    ds_read_b64_tr_b16 v[100:101], v16 offset:8256
    ds_read_b64_tr_b16 v[102:103], v16 offset:10304
    ds_read_b64_tr_b16 v[104:105], v16 offset:8320
    ds_read_b64_tr_b16 v[106:107], v16 offset:10368
    ds_read_b64_tr_b16 v[108:109], v16 offset:8384
    ds_read_b64_tr_b16 v[110:111], v16 offset:10432
    s_add_u32 s98, s86, 114688
    s_waitcnt lgkmcnt(6)
    buffer_store_dwordx4 v[96:99], v2, s[56:59], s98 offen offset:0 sc1
    s_waitcnt lgkmcnt(4)
    buffer_store_dwordx4 v[100:103], v2, s[56:59], s98 offen offset:1024 sc1
    s_add_u32 s98, s86, 458752
    s_waitcnt lgkmcnt(2)
    buffer_store_dwordx4 v[104:107], v2, s[56:59], s98 offen offset:0 sc1
    s_waitcnt lgkmcnt(0)
    buffer_store_dwordx4 v[108:111], v2, s[56:59], s98 offen offset:1024 sc1
    v_readfirstlane_b32 s12, v252
    v_readfirstlane_b32 s13, v253
    s_nop 0
    s_mul_i32 s12, s12, 0x9e3779b1
    s_add_u32 s12, s12, 0x7f4a7c15
    s_mul_i32 s13, s13, 0x85ebca6b
    s_add_u32 s13, s13, 0xc2b2ae35
    v_mov_b32 v254, s12
    v_mov_b32 v255, s13
    s_waitcnt vmcnt(0)
    s_add_u32 s37, s92, 49152
    s_mov_b64 exec, 1
    buffer_store_dwordx2 v[254:255], v11, s[56:59], s37 offen sc1
    s_mov_b64 exec, -1
    s_add_u32 m0, s100, 12288
    s_add_u32 s98, s85, 86016
    buffer_load_dwordx4 v21, s[44:47], s98 offen lds
    s_add_u32 m0, s100, 13312
    s_add_u32 s98, s85, 89600
    buffer_load_dwordx4 v21, s[44:47], s98 offen lds
    s_add_u32 m0, s100, 14336
    s_add_u32 s98, s85, 93184
    buffer_load_dwordx4 v21, s[44:47], s98 offen lds
    s_add_u32 m0, s100, 15360
    s_add_u32 s98, s85, 96768
    buffer_load_dwordx4 v21, s[44:47], s98 offen lds
    s_add_u32 m0, s100, 16384
    s_add_u32 s98, s101, 0
    buffer_load_dwordx4 v3, s[48:51], s98 offen lds
    s_add_u32 m0, s100, 17408
    s_add_u32 s98, s101, 7168
    buffer_load_dwordx4 v4, s[48:51], s98 offen lds
    s_add_u32 m0, s100, 18432
    s_add_u32 s98, s101, 14336
    buffer_load_dwordx4 v3, s[48:51], s98 offen lds
    s_add_u32 m0, s100, 19456
    s_add_u32 s98, s101, 21504
    buffer_load_dwordx4 v4, s[48:51], s98 offen lds
    s_add_u32 m0, s100, 20480
    s_add_u32 s98, s101, 0
    buffer_load_dwordx4 v3, s[52:55], s98 offen lds
    s_add_u32 m0, s100, 21504
    s_add_u32 s98, s101, 7168
    buffer_load_dwordx4 v4, s[52:55], s98 offen lds
    s_add_u32 m0, s100, 22528
    s_add_u32 s98, s101, 14336
    buffer_load_dwordx4 v3, s[52:55], s98 offen lds
    s_add_u32 m0, s100, 23552
    s_add_u32 s98, s101, 21504
    buffer_load_dwordx4 v4, s[52:55], s98 offen lds
    v_lshlrev_b32 v224, 16, v224
    v_lshlrev_b32 v225, 16, v225
    v_lshlrev_b32 v226, 16, v226
    v_mul_f32 v226, 0x3fb8aa3b, v226
    v_exp_f32 v226, v226
    s_nop 0
    v_cvt_pk_bf16_f32 v226, v226, v226
    v_lshlrev_b32 v226, 16, v226
    v_mul_f32 v228, v226, v224
    v_mul_f32 v229, v226, v225
    v_mul_f32 v228, 0x3fb8aa3b, v228
    v_exp_f32 v228, v228
    v_mul_f32 v229, 0x3e22f983, v229
    v_fract_f32 v229, v229
    v_cos_f32 v230, v229
    v_sin_f32 v231, v229
    v_mul_f32 v230, v228, v230
    v_mul_f32 v231, v228, v231
    v_add_f32 v230, -1.0, v230
    v_mul_f32 v228, v224, v224
    v_fmac_f32 v228, v225, v225
    v_rcp_f32 v228, v228
    v_mul_f32 v232, v230, v224
    v_fmac_f32 v232, v231, v225
    v_add_f32 v228, v228, v228
    v_mul_f32 v233, v231, v224
    v_fma_f32 v233, -v230, v225, v233
    v_mul_f32 v232, v232, v228
    v_mul_f32 v233, v233, v228
    v_lshl_add_u32 v5, v1, 3, s100
    ds_write_b64 v5, v[232:233] offset:24576
    v_lshl_add_u32 v5, v12, 6, s100
    s_waitcnt vmcnt(8)
    ds_read_b64_tr_b16 v[112:113], v16 offset:12288
    ds_read_b64_tr_b16 v[114:115], v16 offset:14336
    ds_read_b64_tr_b16 v[116:117], v16 offset:12352
    ds_read_b64_tr_b16 v[118:119], v16 offset:14400
    ds_read_b64_tr_b16 v[120:121], v16 offset:12416
    ds_read_b64_tr_b16 v[122:123], v16 offset:14464
    ds_read_b64_tr_b16 v[124:125], v16 offset:12480
    ds_read_b64_tr_b16 v[126:127], v16 offset:14528
    s_add_u32 s98, s86, 172032
    s_waitcnt lgkmcnt(6)
    buffer_store_dwordx4 v[112:115], v2, s[56:59], s98 offen offset:0 sc1
    s_waitcnt lgkmcnt(4)
    buffer_store_dwordx4 v[116:119], v2, s[56:59], s98 offen offset:1024 sc1
    s_add_u32 s98, s86, 516096
    s_waitcnt lgkmcnt(2)
    buffer_store_dwordx4 v[120:123], v2, s[56:59], s98 offen offset:0 sc1
    s_waitcnt lgkmcnt(0)
    buffer_store_dwordx4 v[124:127], v2, s[56:59], s98 offen offset:1024 sc1
    s_lshl_b32 s98, s88, 3
    s_add_u32 s98, s98, 112
    s_lshl_b32 s86, s98, 11
    s_lshr_b32 s98, s89, 1
    s_mul_i32 s98, s98, 344064
    s_add_u32 s86, s86, s98
    s_and_b32 s98, s89, 1
    s_lshl_b32 s98, s98, 10
    s_add_u32 s86, s86, s98
    s_add_u32 s86, s86, 1048576
    s_waitcnt vmcnt(4)
    ds_read_b128 v[24:27], v17 offset:16384
    ds_read_b128 v[28:31], v17 offset:20480
    ds_read_b128 v[128:131], v5 offset:24576
    ds_read_b128 v[132:135], v5 offset:24592
    ds_read_b128 v[136:139], v5 offset:24608
    ds_read_b128 v[140:143], v5 offset:24624
    ds_read_b128 v[32:35], v18 offset:16384
    ds_read_b128 v[36:39], v18 offset:20480
    ds_read_b128 v[144:147], v5 offset:24704
    ds_read_b128 v[148:151], v5 offset:24720
    ds_read_b128 v[152:155], v5 offset:24736
    ds_read_b128 v[156:159], v5 offset:24752
    s_waitcnt lgkmcnt(6)
    ds_read_b128 v[40:43], v19 offset:16384
    ds_read_b128 v[44:47], v19 offset:20480
    ds_read_b128 v[160:163], v5 offset:24832
    ds_read_b128 v[164:167], v5 offset:24848
    ds_read_b128 v[168:171], v5 offset:24864
    ds_read_b128 v[172:175], v5 offset:24880
    ds_read_b128 v[48:51], v20 offset:16384
    ds_read_b128 v[52:55], v20 offset:20480
    ds_read_b128 v[176:179], v5 offset:24960
    ds_read_b128 v[180:183], v5 offset:24976
    ds_read_b128 v[184:187], v5 offset:24992
    ds_read_b128 v[188:191], v5 offset:25008
    v_lshlrev_b32 v56, 16, v24
    v_and_b32 v57, s15, v24
    v_lshlrev_b32 v58, 16, v28
    v_and_b32 v59, s15, v28
    v_mul_f32 v60, v128, v56
    v_fma_f32 v60, -v129, v58, v60
    v_mul_f32 v61, v130, v57
    v_fma_f32 v61, -v131, v59, v61
    v_mul_f32 v62, -v128, v58
    v_fma_f32 v62, -v129, v56, v62
    v_mul_f32 v63, -v130, v59
    v_fma_f32 v63, -v131, v57, v63
    v_cvt_pk_bf16_f32 v192, v60, v61
    v_cvt_pk_bf16_f32 v196, v62, v63
    v_lshlrev_b32 v56, 16, v25
    v_and_b32 v57, s15, v25
    v_lshlrev_b32 v58, 16, v29
    v_and_b32 v59, s15, v29
    v_mul_f32 v60, v132, v56
    v_fma_f32 v60, -v133, v58, v60
    v_mul_f32 v61, v134, v57
    v_fma_f32 v61, -v135, v59, v61
    v_mul_f32 v62, -v132, v58
    v_fma_f32 v62, -v133, v56, v62
    v_mul_f32 v63, -v134, v59
    v_fma_f32 v63, -v135, v57, v63
    v_cvt_pk_bf16_f32 v193, v60, v61
    v_cvt_pk_bf16_f32 v197, v62, v63
    v_lshlrev_b32 v56, 16, v26
    v_and_b32 v57, s15, v26
    v_lshlrev_b32 v58, 16, v30
    v_and_b32 v59, s15, v30
    v_mul_f32 v60, v136, v56
    v_fma_f32 v60, -v137, v58, v60
    v_mul_f32 v61, v138, v57
    v_fma_f32 v61, -v139, v59, v61
    v_mul_f32 v62, -v136, v58
    v_fma_f32 v62, -v137, v56, v62
    v_mul_f32 v63, -v138, v59
    v_fma_f32 v63, -v139, v57, v63
    v_cvt_pk_bf16_f32 v194, v60, v61
    v_cvt_pk_bf16_f32 v198, v62, v63
    v_lshlrev_b32 v56, 16, v27
    v_and_b32 v57, s15, v27
    v_lshlrev_b32 v58, 16, v31
    v_and_b32 v59, s15, v31
    v_mul_f32 v60, v140, v56
    v_fma_f32 v60, -v141, v58, v60
    v_mul_f32 v61, v142, v57
    v_fma_f32 v61, -v143, v59, v61
    v_mul_f32 v62, -v140, v58
    v_fma_f32 v62, -v141, v56, v62
    v_mul_f32 v63, -v142, v59
    v_fma_f32 v63, -v143, v57, v63
    v_cvt_pk_bf16_f32 v195, v60, v61
    v_cvt_pk_bf16_f32 v199, v62, v63
    s_waitcnt lgkmcnt(15)
    v_lshlrev_b32 v56, 16, v32
    v_and_b32 v57, s15, v32
    v_lshlrev_b32 v58, 16, v36
    v_and_b32 v59, s15, v36
    v_mul_f32 v60, v144, v56
    v_fma_f32 v60, -v145, v58, v60
    v_mul_f32 v61, v146, v57
    v_fma_f32 v61, -v147, v59, v61
    v_mul_f32 v62, -v144, v58
    v_fma_f32 v62, -v145, v56, v62
    v_mul_f32 v63, -v146, v59
    v_fma_f32 v63, -v147, v57, v63
    v_cvt_pk_bf16_f32 v200, v60, v61
    v_cvt_pk_bf16_f32 v204, v62, v63
    v_lshlrev_b32 v56, 16, v33
    v_and_b32 v57, s15, v33
    v_lshlrev_b32 v58, 16, v37
    v_and_b32 v59, s15, v37
    s_waitcnt lgkmcnt(14)
    v_mul_f32 v60, v148, v56
    v_fma_f32 v60, -v149, v58, v60
    v_mul_f32 v61, v150, v57
    v_fma_f32 v61, -v151, v59, v61
    v_mul_f32 v62, -v148, v58
    v_fma_f32 v62, -v149, v56, v62
    v_mul_f32 v63, -v150, v59
    v_fma_f32 v63, -v151, v57, v63
    v_cvt_pk_bf16_f32 v201, v60, v61
    v_cvt_pk_bf16_f32 v205, v62, v63
    v_lshlrev_b32 v56, 16, v34
    v_and_b32 v57, s15, v34
    v_lshlrev_b32 v58, 16, v38
    v_and_b32 v59, s15, v38
    s_waitcnt lgkmcnt(13)
    v_mul_f32 v60, v152, v56
    v_fma_f32 v60, -v153, v58, v60
    v_mul_f32 v61, v154, v57
    v_fma_f32 v61, -v155, v59, v61
    v_mul_f32 v62, -v152, v58
    v_fma_f32 v62, -v153, v56, v62
    v_mul_f32 v63, -v154, v59
    v_fma_f32 v63, -v155, v57, v63
    v_cvt_pk_bf16_f32 v202, v60, v61
    v_cvt_pk_bf16_f32 v206, v62, v63
    v_lshlrev_b32 v56, 16, v35
    v_and_b32 v57, s15, v35
    v_lshlrev_b32 v58, 16, v39
    v_and_b32 v59, s15, v39
    s_waitcnt lgkmcnt(12)
    v_mul_f32 v60, v156, v56
    v_fma_f32 v60, -v157, v58, v60
    v_mul_f32 v61, v158, v57
    v_fma_f32 v61, -v159, v59, v61
    v_mul_f32 v62, -v156, v58
    v_fma_f32 v62, -v157, v56, v62
    v_mul_f32 v63, -v158, v59
    v_fma_f32 v63, -v159, v57, v63
    v_cvt_pk_bf16_f32 v203, v60, v61
    v_cvt_pk_bf16_f32 v207, v62, v63
    s_waitcnt vmcnt(0)
    s_add_u32 s37, s92, 52224
    s_mov_b64 exec, 1
    buffer_store_dwordx2 v[254:255], v11, s[56:59], s37 offen sc1
    s_mov_b64 exec, -1
    s_waitcnt lgkmcnt(11)
    v_lshlrev_b32 v56, 16, v40
    v_and_b32 v57, s15, v40
    s_waitcnt lgkmcnt(10)
    v_lshlrev_b32 v58, 16, v44
    v_and_b32 v59, s15, v44
    s_waitcnt lgkmcnt(9)
    v_mul_f32 v60, v160, v56
    v_fma_f32 v60, -v161, v58, v60
    v_mul_f32 v61, v162, v57
    v_fma_f32 v61, -v163, v59, v61
    v_mul_f32 v62, -v160, v58
    v_fma_f32 v62, -v161, v56, v62
    v_mul_f32 v63, -v162, v59
    v_fma_f32 v63, -v163, v57, v63
    v_cvt_pk_bf16_f32 v208, v60, v61
    v_cvt_pk_bf16_f32 v212, v62, v63
    v_lshlrev_b32 v56, 16, v41
    v_and_b32 v57, s15, v41
    v_lshlrev_b32 v58, 16, v45
    v_and_b32 v59, s15, v45
    s_waitcnt lgkmcnt(8)
    v_mul_f32 v60, v164, v56
    v_fma_f32 v60, -v165, v58, v60
    v_mul_f32 v61, v166, v57
    v_fma_f32 v61, -v167, v59, v61
    v_mul_f32 v62, -v164, v58
    v_fma_f32 v62, -v165, v56, v62
    v_mul_f32 v63, -v166, v59
    v_fma_f32 v63, -v167, v57, v63
    v_cvt_pk_bf16_f32 v209, v60, v61
    v_cvt_pk_bf16_f32 v213, v62, v63
    v_lshlrev_b32 v56, 16, v42
    v_and_b32 v57, s15, v42
    v_lshlrev_b32 v58, 16, v46
    v_and_b32 v59, s15, v46
    s_waitcnt lgkmcnt(7)
    v_mul_f32 v60, v168, v56
    v_fma_f32 v60, -v169, v58, v60
    v_mul_f32 v61, v170, v57
    v_fma_f32 v61, -v171, v59, v61
    v_mul_f32 v62, -v168, v58
    v_fma_f32 v62, -v169, v56, v62
    v_mul_f32 v63, -v170, v59
    v_fma_f32 v63, -v171, v57, v63
    v_cvt_pk_bf16_f32 v210, v60, v61
    v_cvt_pk_bf16_f32 v214, v62, v63
    v_lshlrev_b32 v56, 16, v43
    v_and_b32 v57, s15, v43
    v_lshlrev_b32 v58, 16, v47
    v_and_b32 v59, s15, v47
    s_waitcnt lgkmcnt(6)
    v_mul_f32 v60, v172, v56
    v_fma_f32 v60, -v173, v58, v60
    v_mul_f32 v61, v174, v57
    v_fma_f32 v61, -v175, v59, v61
    v_mul_f32 v62, -v172, v58
    v_fma_f32 v62, -v173, v56, v62
    v_mul_f32 v63, -v174, v59
    v_fma_f32 v63, -v175, v57, v63
    v_cvt_pk_bf16_f32 v211, v60, v61
    v_cvt_pk_bf16_f32 v215, v62, v63
    s_waitcnt lgkmcnt(5)
    v_lshlrev_b32 v56, 16, v48
    v_and_b32 v57, s15, v48
    s_waitcnt lgkmcnt(4)
    v_lshlrev_b32 v58, 16, v52
    v_and_b32 v59, s15, v52
    s_waitcnt lgkmcnt(3)
    v_mul_f32 v60, v176, v56
    v_fma_f32 v60, -v177, v58, v60
    v_mul_f32 v61, v178, v57
    v_fma_f32 v61, -v179, v59, v61
    v_mul_f32 v62, -v176, v58
    v_fma_f32 v62, -v177, v56, v62
    v_mul_f32 v63, -v178, v59
    v_fma_f32 v63, -v179, v57, v63
    v_cvt_pk_bf16_f32 v216, v60, v61
    v_cvt_pk_bf16_f32 v220, v62, v63
    v_lshlrev_b32 v56, 16, v49
    v_and_b32 v57, s15, v49
    v_lshlrev_b32 v58, 16, v53
    v_and_b32 v59, s15, v53
    s_waitcnt lgkmcnt(2)
    v_mul_f32 v60, v180, v56
    v_fma_f32 v60, -v181, v58, v60
    v_mul_f32 v61, v182, v57
    v_fma_f32 v61, -v183, v59, v61
    v_mul_f32 v62, -v180, v58
    v_fma_f32 v62, -v181, v56, v62
    v_mul_f32 v63, -v182, v59
    v_fma_f32 v63, -v183, v57, v63
    v_cvt_pk_bf16_f32 v217, v60, v61
    v_cvt_pk_bf16_f32 v221, v62, v63
    v_lshlrev_b32 v56, 16, v50
    v_and_b32 v57, s15, v50
    v_lshlrev_b32 v58, 16, v54
    v_and_b32 v59, s15, v54
    s_waitcnt lgkmcnt(1)
    v_mul_f32 v60, v184, v56
    v_fma_f32 v60, -v185, v58, v60
    v_mul_f32 v61, v186, v57
    v_fma_f32 v61, -v187, v59, v61
    v_mul_f32 v62, -v184, v58
    v_fma_f32 v62, -v185, v56, v62
    v_mul_f32 v63, -v186, v59
    v_fma_f32 v63, -v187, v57, v63
    v_cvt_pk_bf16_f32 v218, v60, v61
    v_cvt_pk_bf16_f32 v222, v62, v63
    v_lshlrev_b32 v56, 16, v51
    v_and_b32 v57, s15, v51
    v_lshlrev_b32 v58, 16, v55
    v_and_b32 v59, s15, v55
    s_waitcnt lgkmcnt(0)
    v_mul_f32 v60, v188, v56
    v_fma_f32 v60, -v189, v58, v60
    v_mul_f32 v61, v190, v57
    v_fma_f32 v61, -v191, v59, v61
    v_mul_f32 v62, -v188, v58
    v_fma_f32 v62, -v189, v56, v62
    v_mul_f32 v63, -v190, v59
    v_fma_f32 v63, -v191, v57, v63
    v_cvt_pk_bf16_f32 v219, v60, v61
    v_cvt_pk_bf16_f32 v223, v62, v63
    s_cmp_ge_u32 s84, 98
    s_cbranch_scc1 L_prep_fin
    s_add_u32 s98, s86, 0
    s_add_u32 s99, s98, 4096
    buffer_store_dwordx4 v[192:195], v2, s[56:59], s98 offen sc1
    buffer_store_dwordx4 v[196:199], v2, s[56:59], s99 offen sc1
    s_add_u32 s98, s86, 2048
    s_add_u32 s99, s98, 4096
    buffer_store_dwordx4 v[200:203], v2, s[56:59], s98 offen sc1
    buffer_store_dwordx4 v[204:207], v2, s[56:59], s99 offen sc1
    s_add_u32 s98, s86, 8192
    s_add_u32 s99, s98, 4096
    buffer_store_dwordx4 v[208:211], v2, s[56:59], s98 offen sc1
    buffer_store_dwordx4 v[212:215], v2, s[56:59], s99 offen sc1
    s_add_u32 s98, s86, 10240
    s_add_u32 s99, s98, 4096
    buffer_store_dwordx4 v[216:219], v2, s[56:59], s98 offen sc1
    buffer_store_dwordx4 v[220:223], v2, s[56:59], s99 offen sc1
    s_lshl_b32 s98, s89, 3
    s_add_u32 s98, s98, s88
    s_lshl_b32 s98, s98, 3
    s_waitcnt vmcnt(0)
    s_add_u32 s37, s98, 53248
    s_mov_b64 exec, 1
    buffer_store_dwordx2 v[254:255], v11, s[56:59], s37 offen sc1
    s_mov_b64 exec, -1
L_prep_fin:
L_exit:
    s_endpgm
L_code_end:
.section .rodata,"a"
.p2align 6
.amdhsa_kernel parallel_sum__ssm_conv_s5__dense_activation_silu__prompt_kernel
  .amdhsa_next_free_vgpr 512
  .amdhsa_next_free_sgpr 102
  .amdhsa_accum_offset 256
  .amdhsa_group_segment_fixed_size 0
  .amdhsa_kernarg_size 120
  .amdhsa_user_sgpr_count 2
  .amdhsa_user_sgpr_kernarg_segment_ptr 1
  .amdhsa_system_sgpr_workgroup_id_x 1
  .amdhsa_float_denorm_mode_32 3
.end_amdhsa_kernel
```
